```python
import torch

def _softmax(x, axis=-1):
    return torch.softmax(x, dim=axis)
def _gelu(x):
    return torch.nn.functional.gelu(x, approximate="tanh")
def _silu(x):
    return torch.nn.functional.silu(x)
def _sigmoid(x):
    return torch.sigmoid(x)
def _layernorm(x, axis=-1, eps=1e-5):
    m = x.mean(dim=axis, keepdim=True)
    v = x.var(dim=axis, keepdim=True, unbiased=False)
    return (x - m) / torch.sqrt(v + eps)
def _scatter_add(tgt, idx, src, axis=0):
    return tgt.clone().index_add_(axis, idx, src)
def _segment_sum(src, seg, n):
    out = torch.zeros((n,) + src.shape[1:], dtype=src.dtype)
    return out.index_add_(0, seg, src)
def _pad(x, pw):
    flat = tuple(v for pair in reversed(pw) for v in pair)
    return torch.nn.functional.pad(x, flat)

kernel_name = 'standalone__linear_attn_elu__prompt'

def setup_inputs():

    _w = (lambda a: (lambda t: t.to(torch.bfloat16) if t.is_floating_point() else t)(torch.as_tensor(a)))
    B, H, S, D = 1, 32, 2048, 128
    return {
        "q": _w((lambda *s: torch.randn(*s, dtype=torch.bfloat16) * 0.05)(B, H, S, D)),
        "k": _w((lambda *s: torch.randn(*s, dtype=torch.bfloat16) * 0.05)(B, H, S, D)),
        "v": _w((lambda *s: torch.randn(*s, dtype=torch.bfloat16) * 0.05)(B, H, S, D)),
    }

def reference(q, k, v):
    phi_q = torch.where(q > 0, q + 1, torch.exp(q)) + 1e-6
    phi_k = torch.where(k > 0, k + 1, torch.exp(k)) + 1e-6
    kv = torch.einsum("bhsd,bhse->bhde", phi_k, v)
    z = torch.einsum("bhsd->bhd", phi_k)
    num = torch.einsum("bhqd,bhde->bhqe", phi_q, kv)
    den = torch.einsum("bhqd,bhd->bhq", phi_q, z)[..., None] + 1e-6
    return num / den
```

```asm
; @launch grid=(256,1,1) block=(512,1,1) lds=155920
.amdgcn_target "amdgcn-amd-amdhsa--gfx950"
.text
.globl standalone__linear_attn_elu__prompt_kernel
.p2align 8
.type standalone__linear_attn_elu__prompt_kernel,@function
standalone__linear_attn_elu__prompt_kernel:
    s_cmp_ge_u32 s2, 256
    s_cbranch_scc1 standalone__linear_attn_elu__prompt_kernel_end
    s_load_dwordx4 s[36:39], s[0:1], 0
    s_load_dwordx4 s[40:43], s[0:1], 16
    s_load_dwordx4 s[44:47], s[0:1], 32
    v_lshrrev_b32 v2, 6, v0
    v_and_b32 v1, 63, v0
    v_readfirstlane_b32 s4, v2
    s_and_b32 s5, s2, 7
    s_lshl_b32 s5, s5, 5
    s_lshr_b32 s6, s2, 3
    s_add_u32 s34, s5, s6
    s_and_b32 s7, s34, 7
    s_lshr_b32 s35, s34, 3
    s_lshl_b32 s33, s35, 19
    s_and_b32 s5, s7, 3
    s_lshl_b32 s5, s5, 17
    s_add_u32 s33, s33, s5
    s_lshl_b32 s5, s4, 11
    s_add_u32 s33, s33, s5
    s_lshr_b32 s5, s7, 2
    s_lshl_b32 s5, s5, 7
    s_add_u32 s48, s33, s5
    s_and_b32 s5, s7, 1
    s_lshl_b32 s5, s5, 7
    s_add_u32 s50, s33, s5
    s_xor_b32 s49, s50, 128
    s_lshl_b32 s55, s4, 10
    s_add_u32 s55, s55, 65536
    s_mov_b32 s10, 16777216
    s_mov_b32 s14, 16777216
    s_mov_b32 s18, 16777216
    s_mov_b32 s22, 16777216
    s_mov_b32 s26, 0x10000000
    s_mov_b32 s11, 0x20000
    s_mov_b32 s15, 0x20000
    s_mov_b32 s19, 0x20000
    s_mov_b32 s23, 0x20000
    s_mov_b32 s27, 0x20000
    v_lshrrev_b32 v8, 3, v1
    v_and_b32 v10, 7, v1
    v_lshlrev_b32 v9, 4, v10
    v_lshl_add_u32 v2, v8, 8, v9
    v_and_b32 v9, 6, v8
    v_lshlrev_b32 v9, 4, v9
    v_xor_b32 v3, v2, v9
    s_lshl_b32 s56, s35, 11
    s_lshl_b32 s51, s4, 8
    s_add_u32 s51, s51, s56
    s_lshl_b32 s52, s34, 8
    v_mov_b32 v11, 21037056
    s_waitcnt lgkmcnt(0)
    s_mov_b32 s8, s38
    s_mov_b32 s9, s39
    s_mov_b32 s12, s40
    s_mov_b32 s13, s41
    s_mov_b32 s24, s46
    s_mov_b32 s25, s47
    s_mov_b32 s16, s36
    s_mov_b32 s17, s37
    s_mov_b32 s20, s42
    s_mov_b32 s21, s43
    s_mov_b32 s28, s44
    s_mov_b32 s29, s45
    s_mov_b32 s96, s42
    s_mov_b32 s97, s43
    s_mov_b32 s98, 16777216
    s_mov_b32 s99, 0x20000
    buffer_load_dwordx4 v[16:19], v2, s[8:11], s48 offen nt
    s_add_u32 s48, s48, 16384
    s_add_u32 m0, s55, 0
    s_nop 0
    buffer_load_dwordx4 v3, s[12:15], s49 offen nt lds
    s_add_u32 s49, s49, 16384
    buffer_load_dwordx4 v[20:23], v2, s[8:11], s48 offen nt
    s_add_u32 s48, s48, 16384
    s_add_u32 m0, s55, 8192
    s_nop 0
    buffer_load_dwordx4 v3, s[12:15], s49 offen nt lds
    s_add_u32 s49, s49, 16384
    buffer_load_dword v130, v11, s[24:27], s51 offen sc1
    s_getreg_b32 s33, hwreg(HW_REG_XCC_ID, 0, 4)
    v_mov_b32 v132, 155904
    v_mov_b32 v133, 0
    ds_write_b32 v132, v133
    v_mov_b32 v131, s33
    s_or_b32 s33, s33, 0x80
    s_lshl_b32 s92, s4, 10
    v_lshlrev_b32 v9, 4, v1
    v_mov_b32 v104, -1
    v_mov_b32 v105, -1
    v_mov_b32 v106, -1
    v_mov_b32 v107, -1
    s_mov_b32 s30, 0x3fb8aa3b
    s_mov_b32 s31, 0x358637bd
    s_mov_b32 s32, 0xffff0000
    s_mov_b32 s54, 0
    s_lshl_b32 s3, s34, 16
    s_lshl_b32 s5, s4, 13
    s_add_u32 s3, s3, s5
    s_lshr_b32 s57, s4, 2
    s_and_b32 s58, s4, 3
    s_cmp_eq_u32 s58, s57
    s_cselect_b32 s53, 1, 0
    v_lshrrev_b32 v13, 1, v8
    v_and_b32 v14, 1, v8
    v_xor_b32 v13, v13, v14
    v_lshrrev_b32 v14, 2, v10
    v_lshlrev_b32 v14, 1, v14
    v_xor_b32 v13, v13, v14
    v_and_b32 v14, 3, v1
    v_lshlrev_b32 v14, 3, v14
    v_lshl_add_u32 v13, v13, 5, v14
    v_lshl_add_u32 v13, v8, 7, v13
    s_lshl_b32 s5, s4, 10
    v_add_u32 v4, s5, v13
    v_xor_b32 v5, 32, v4
    v_lshrrev_b32 v13, 2, v1
    v_lshl_add_u32 v14, v13, 7, v14
    v_bfe_u32 v15, v1, 3, 2
    v_xor_b32 v8, s58, v15
    v_lshl_add_u32 v8, v8, 5, v14
    v_add_u32 v8, 65536, v8
    v_add_u32 v216, 0x8000, v8
    v_and_b32 v13, 1, v13
    v_xor_b32 v15, v15, v13
    s_lshl_b32 s5, s57, 1
    v_xor_b32 v15, s5, v15
    v_lshl_add_u32 v6, v15, 5, v14
    v_xor_b32 v7, 32, v6
    v_lshrrev_b32 v13, 4, v1
    v_lshlrev_b32 v13, 4, v13
    v_xor_b32 v220, v2, v13
    v_xor_b32 v221, 64, v220
    v_add_u32 v221, 2048, v221
    v_bfe_u32 v13, v1, 3, 1
    v_lshlrev_b32 v13, 13, v13
    v_lshl_add_u32 v13, v10, 7, v13
    v_bfe_u32 v14, v1, 1, 3
    v_lshrrev_b32 v15, 4, v1
    v_xor_b32 v14, v14, v15
    v_lshl_add_u32 v13, v14, 4, v13
    v_add_u32 v218, s92, v13
    v_xor_b32 v219, 64, v218
    s_bfe_u32 s6, s7, 0x10001
    s_lshl_b32 s5, s6, 3
    s_lshl_b32 s60, 0x00ff00ff, s5
    s_mov_b32 s61, s60
    s_and_b32 s5, s7, 1
    s_lshl_b32 s5, s5, 2
    s_or_b32 s5, s5, s6
    s_and_b32 s59, s58, 2
    s_or_b32 s5, s5, s59
    v_xor_b32 v13, s5, v10
    v_lshlrev_b32 v13, 4, v13
    v_lshrrev_b32 v14, 4, v1
    v_lshlrev_b32 v138, 4, v10
    v_lshl_add_u32 v10, v14, 9, v13
    v_lshl_add_u32 v138, v14, 7, v138
    v_bfe_u32 v13, v1, 3, 1
    v_lshl_add_u32 v136, v13, 9, v138
    v_xor_b32 v13, s6, v13
    v_lshl_add_u32 v139, v13, 9, v138
    v_lshlrev_b32 v13, 17, v13
    s_lshl_b32 s59, s34, 16
    s_add_u32 s59, s59, s92
    s_lshl_b32 s6, s6, 9
    s_add_u32 s6, s6, s59
    s_xor_b32 s6, s6, 65536
    v_xor_b32 v13, s6, v13
    v_add_u32 v137, v13, v138
    s_lshl_b32 s63, s34, 13
    s_lshl_b32 s5, s4, 9
    s_add_u32 s62, s63, s5
    s_add_u32 s62, s62, 16781312
    s_xor_b32 s95, s62, 16384
    s_lshl_b32 s5, s58, 7
    s_add_u32 s63, s63, s5
    s_lshl_b32 s5, s57, 11
    s_add_u32 s63, s63, s5
    s_add_u32 s63, s63, 16777216
    v_and_b32 v134, 1, v1
    v_lshlrev_b32 v134, 9, v134
    s_xor_b32 s5, s52, 256
    v_xor_b32 v134, s5, v134
    s_mov_b32 s93, 20971520
    v_mov_b32 v120, 0x3f803f80
    v_mov_b32 v121, 0x3f803f80
    v_mov_b32 v122, 0x3f803f80
    v_mov_b32 v123, 0x3f803f80
    s_waitcnt vmcnt(4)
    v_lshlrev_b32 v28, 16, v16
    v_and_b32 v29, s32, v16
    v_lshlrev_b32 v30, 16, v17
    v_and_b32 v31, s32, v17
    v_lshlrev_b32 v32, 16, v18
    v_and_b32 v33, s32, v18
    v_lshlrev_b32 v34, 16, v19
    v_and_b32 v35, s32, v19
    buffer_load_dwordx4 v[16:19], v2, s[8:11], s48 offen nt
    s_add_u32 s48, s48, 16384
    s_lshl_b32 s5, s34, 13
    s_add_u32 s5, s5, s92
    s_add_u32 s5, s5, 16777216
    buffer_store_dwordx4 v[104:107], v9, s[24:27], s5 offen
    v_mul_f32 v36, s30, v28
    v_mul_f32 v37, s30, v29
    v_mul_f32 v38, s30, v30
    v_mul_f32 v39, s30, v31
    v_mul_f32 v40, s30, v32
    v_mul_f32 v41, s30, v33
    v_mul_f32 v42, s30, v34
    v_mul_f32 v43, s30, v35
    v_exp_f32_e64 v36, v36 clamp
    v_max_f32 v28, s31, v28
    v_exp_f32_e64 v37, v37 clamp
    v_max_f32 v29, s31, v29
    v_exp_f32_e64 v38, v38 clamp
    v_max_f32 v30, s31, v30
    v_exp_f32_e64 v39, v39 clamp
    v_max_f32 v31, s31, v31
    v_exp_f32_e64 v40, v40 clamp
    v_max_f32 v32, s31, v32
    v_exp_f32_e64 v41, v41 clamp
    v_max_f32 v33, s31, v33
    v_exp_f32_e64 v42, v42 clamp
    v_max_f32 v34, s31, v34
    v_exp_f32_e64 v43, v43 clamp
    v_max_f32 v35, s31, v35
    v_add_f32 v28, v36, v28
    v_add_f32 v29, v37, v29
    v_add_f32 v30, v38, v30
    v_add_f32 v31, v39, v31
    v_add_f32 v32, v40, v32
    v_add_f32 v33, v41, v33
    v_add_f32 v34, v42, v34
    v_add_f32 v35, v43, v35
    v_cvt_pk_bf16_f32 v44, v28, v29
    v_cvt_pk_bf16_f32 v45, v30, v31
    v_cvt_pk_bf16_f32 v46, v32, v33
    v_cvt_pk_bf16_f32 v47, v34, v35
    ds_write_b64 v4, v[44:45] offset:0
    ds_write_b64 v5, v[46:47] offset:0
    s_waitcnt vmcnt(5)
    s_add_u32 m0, s55, 16384
    s_nop 0
    buffer_load_dwordx4 v3, s[12:15], s49 offen nt lds
    s_add_u32 s49, s49, 16384
    s_waitcnt lgkmcnt(0)
    s_barrier
    ds_read_b64_tr_b16 v[224:225], v6 offset:0
    ds_read_b64_tr_b16 v[226:227], v6 offset:2048
    ds_read_b64_tr_b16 v[228:229], v7 offset:0
    ds_read_b64_tr_b16 v[230:231], v7 offset:2048
    ds_read_b64_tr_b16 v[232:233], v6 offset:4096
    ds_read_b64_tr_b16 v[234:235], v6 offset:6144
    ds_read_b64_tr_b16 v[236:237], v7 offset:4096
    ds_read_b64_tr_b16 v[238:239], v7 offset:6144
    ds_read_b64_tr_b16 v[80:81], v8 offset:0
    ds_read_b64_tr_b16 v[82:83], v8 offset:2048
    ds_read_b64_tr_b16 v[84:85], v8 offset:4096
    ds_read_b64_tr_b16 v[86:87], v8 offset:6144
    s_waitcnt vmcnt(5)
    v_lshlrev_b32 v28, 16, v20
    v_and_b32 v29, s32, v20
    v_lshlrev_b32 v30, 16, v21
    v_and_b32 v31, s32, v21
    v_lshlrev_b32 v32, 16, v22
    v_and_b32 v33, s32, v22
    v_lshlrev_b32 v34, 16, v23
    v_and_b32 v35, s32, v23
    buffer_load_dwordx4 v[20:23], v2, s[8:11], s48 offen nt
    s_add_u32 s48, s48, 16384
    s_add_u32 s5, s52, 20971520
    s_lshl_b32 s6, s4, 5
    s_add_u32 s5, s5, s6
    s_mov_b64 exec, 3
    buffer_store_dwordx4 v[104:107], v9, s[24:27], s5 offen
    s_mov_b64 exec, -1
    v_mul_f32 v36, s30, v28
    v_mul_f32 v37, s30, v29
    v_mul_f32 v38, s30, v30
    v_mul_f32 v39, s30, v31
    v_mul_f32 v40, s30, v32
    v_mul_f32 v41, s30, v33
    v_mul_f32 v42, s30, v34
    v_mul_f32 v43, s30, v35
    s_waitcnt lgkmcnt(0)
    v_mfma_f32_16x16x32_bf16 v[96:99], v[224:227], v[80:83], 0
    v_exp_f32_e64 v36, v36 clamp
    v_max_f32 v28, s31, v28
    v_exp_f32_e64 v37, v37 clamp
    v_max_f32 v29, s31, v29
    v_mfma_f32_16x16x32_bf16 v[100:103], v[228:231], v[80:83], 0
    v_exp_f32_e64 v38, v38 clamp
    v_max_f32 v30, s31, v30
    v_exp_f32_e64 v39, v39 clamp
    v_max_f32 v31, s31, v31
    v_mfma_f32_16x16x32_bf16 v[96:99], v[232:235], v[84:87], v[96:99]
    v_exp_f32_e64 v40, v40 clamp
    v_max_f32 v32, s31, v32
    v_exp_f32_e64 v41, v41 clamp
    v_max_f32 v33, s31, v33
    v_mfma_f32_16x16x32_bf16 v[100:103], v[236:239], v[84:87], v[100:103]
    v_exp_f32_e64 v42, v42 clamp
    v_max_f32 v34, s31, v34
    v_exp_f32_e64 v43, v43 clamp
    v_max_f32 v35, s31, v35
    s_cmp_eq_u32 s53, 0
    s_cbranch_scc1 standalone__linear_attn_elu__prompt_kernel_nz0
    v_mfma_f32_16x16x32_bf16 v[112:115], v[224:227], v[120:123], 0
    v_mfma_f32_16x16x32_bf16 v[116:119], v[228:231], v[120:123], 0
    v_mfma_f32_16x16x32_bf16 v[112:115], v[232:235], v[120:123], v[112:115]
    v_mfma_f32_16x16x32_bf16 v[116:119], v[236:239], v[120:123], v[116:119]
standalone__linear_attn_elu__prompt_kernel_nz0:
    v_add_f32 v28, v36, v28
    v_add_f32 v29, v37, v29
    v_add_f32 v30, v38, v30
    v_add_f32 v31, v39, v31
    v_add_f32 v32, v40, v32
    v_add_f32 v33, v41, v33
    v_add_f32 v34, v42, v34
    v_add_f32 v35, v43, v35
    v_cvt_pk_bf16_f32 v44, v28, v29
    v_cvt_pk_bf16_f32 v45, v30, v31
    v_cvt_pk_bf16_f32 v46, v32, v33
    v_cvt_pk_bf16_f32 v47, v34, v35
    ds_write_b64 v4, v[44:45] offset:8192
    ds_write_b64 v5, v[46:47] offset:8192
    s_waitcnt vmcnt(6)
    s_add_u32 m0, s55, 24576
    s_nop 0
    buffer_load_dwordx4 v3, s[12:15], s49 offen nt lds
    s_add_u32 s49, s49, 16384
    s_waitcnt lgkmcnt(0)
    s_barrier
    ds_read_b64_tr_b16 v[240:241], v6 offset:8192
    ds_read_b64_tr_b16 v[242:243], v6 offset:10240
    ds_read_b64_tr_b16 v[244:245], v7 offset:8192
    ds_read_b64_tr_b16 v[246:247], v7 offset:10240
    ds_read_b64_tr_b16 v[248:249], v6 offset:12288
    ds_read_b64_tr_b16 v[250:251], v6 offset:14336
    ds_read_b64_tr_b16 v[252:253], v7 offset:12288
    ds_read_b64_tr_b16 v[254:255], v7 offset:14336
    ds_read_b64_tr_b16 v[80:81], v8 offset:8192
    ds_read_b64_tr_b16 v[82:83], v8 offset:10240
    ds_read_b64_tr_b16 v[84:85], v8 offset:12288
    ds_read_b64_tr_b16 v[86:87], v8 offset:14336
    s_waitcnt vmcnt(5)
    v_lshlrev_b32 v28, 16, v16
    v_and_b32 v29, s32, v16
    v_lshlrev_b32 v30, 16, v17
    v_and_b32 v31, s32, v17
    v_lshlrev_b32 v32, 16, v18
    v_and_b32 v33, s32, v18
    v_lshlrev_b32 v34, 16, v19
    v_and_b32 v35, s32, v19
    buffer_load_dwordx4 v[16:19], v2, s[8:11], s48 offen nt
    s_add_u32 s48, s48, 16384
    v_mul_f32 v36, s30, v28
    v_mul_f32 v37, s30, v29
    v_mul_f32 v38, s30, v30
    v_mul_f32 v39, s30, v31
    v_mul_f32 v40, s30, v32
    v_mul_f32 v41, s30, v33
    v_mul_f32 v42, s30, v34
    v_mul_f32 v43, s30, v35
    s_waitcnt lgkmcnt(0)
    v_mfma_f32_16x16x32_bf16 v[96:99], v[240:243], v[80:83], v[96:99]
    v_exp_f32_e64 v36, v36 clamp
    v_max_f32 v28, s31, v28
    v_exp_f32_e64 v37, v37 clamp
    v_max_f32 v29, s31, v29
    v_mfma_f32_16x16x32_bf16 v[100:103], v[244:247], v[80:83], v[100:103]
    v_exp_f32_e64 v38, v38 clamp
    v_max_f32 v30, s31, v30
    v_exp_f32_e64 v39, v39 clamp
    v_max_f32 v31, s31, v31
    v_mfma_f32_16x16x32_bf16 v[96:99], v[248:251], v[84:87], v[96:99]
    v_exp_f32_e64 v40, v40 clamp
    v_max_f32 v32, s31, v32
    v_exp_f32_e64 v41, v41 clamp
    v_max_f32 v33, s31, v33
    v_mfma_f32_16x16x32_bf16 v[100:103], v[252:255], v[84:87], v[100:103]
    v_exp_f32_e64 v42, v42 clamp
    v_max_f32 v34, s31, v34
    v_exp_f32_e64 v43, v43 clamp
    v_max_f32 v35, s31, v35
    s_cmp_eq_u32 s53, 0
    s_cbranch_scc1 standalone__linear_attn_elu__prompt_kernel_nz1
    v_mfma_f32_16x16x32_bf16 v[112:115], v[240:243], v[120:123], v[112:115]
    v_mfma_f32_16x16x32_bf16 v[116:119], v[244:247], v[120:123], v[116:119]
    v_mfma_f32_16x16x32_bf16 v[112:115], v[248:251], v[120:123], v[112:115]
    v_mfma_f32_16x16x32_bf16 v[116:119], v[252:255], v[120:123], v[116:119]
standalone__linear_attn_elu__prompt_kernel_nz1:
    v_add_f32 v28, v36, v28
    v_add_f32 v29, v37, v29
    v_add_f32 v30, v38, v30
    v_add_f32 v31, v39, v31
    v_add_f32 v32, v40, v32
    v_add_f32 v33, v41, v33
    v_add_f32 v34, v42, v34
    v_add_f32 v35, v43, v35
    v_cvt_pk_bf16_f32 v44, v28, v29
    v_cvt_pk_bf16_f32 v45, v30, v31
    v_cvt_pk_bf16_f32 v46, v32, v33
    v_cvt_pk_bf16_f32 v47, v34, v35
    ds_write_b64 v4, v[44:45] offset:16384
    ds_write_b64 v5, v[46:47] offset:16384
    s_waitcnt vmcnt(4)
    s_add_u32 m0, s55, 32768
    s_nop 0
    buffer_load_dwordx4 v3, s[12:15], s49 offen nt lds
    s_add_u32 s49, s49, 16384
    s_waitcnt lgkmcnt(0)
    s_barrier
    ds_read_b64_tr_b16 v[48:49], v6 offset:16384
    ds_read_b64_tr_b16 v[50:51], v6 offset:18432
    ds_read_b64_tr_b16 v[52:53], v7 offset:16384
    ds_read_b64_tr_b16 v[54:55], v7 offset:18432
    ds_read_b64_tr_b16 v[56:57], v6 offset:20480
    ds_read_b64_tr_b16 v[58:59], v6 offset:22528
    ds_read_b64_tr_b16 v[60:61], v7 offset:20480
    ds_read_b64_tr_b16 v[62:63], v7 offset:22528
    ds_read_b64_tr_b16 v[80:81], v8 offset:16384
    ds_read_b64_tr_b16 v[82:83], v8 offset:18432
    ds_read_b64_tr_b16 v[84:85], v8 offset:20480
    ds_read_b64_tr_b16 v[86:87], v8 offset:22528
    s_waitcnt vmcnt(4)
    v_lshlrev_b32 v28, 16, v20
    v_and_b32 v29, s32, v20
    v_lshlrev_b32 v30, 16, v21
    v_and_b32 v31, s32, v21
    v_lshlrev_b32 v32, 16, v22
    v_and_b32 v33, s32, v22
    v_lshlrev_b32 v34, 16, v23
    v_and_b32 v35, s32, v23
    buffer_load_dwordx4 v[20:23], v2, s[8:11], s48 offen nt
    s_add_u32 s48, s48, 16384
    v_mul_f32 v36, s30, v28
    v_mul_f32 v37, s30, v29
    v_mul_f32 v38, s30, v30
    v_mul_f32 v39, s30, v31
    v_mul_f32 v40, s30, v32
    v_mul_f32 v41, s30, v33
    v_mul_f32 v42, s30, v34
    v_mul_f32 v43, s30, v35
    s_waitcnt lgkmcnt(0)
    v_mfma_f32_16x16x32_bf16 v[96:99], v[48:51], v[80:83], v[96:99]
    v_exp_f32_e64 v36, v36 clamp
    v_max_f32 v28, s31, v28
    v_exp_f32_e64 v37, v37 clamp
    v_max_f32 v29, s31, v29
    v_mfma_f32_16x16x32_bf16 v[100:103], v[52:55], v[80:83], v[100:103]
    v_exp_f32_e64 v38, v38 clamp
    v_max_f32 v30, s31, v30
    v_exp_f32_e64 v39, v39 clamp
    v_max_f32 v31, s31, v31
    v_mfma_f32_16x16x32_bf16 v[96:99], v[56:59], v[84:87], v[96:99]
    v_exp_f32_e64 v40, v40 clamp
    v_max_f32 v32, s31, v32
    v_exp_f32_e64 v41, v41 clamp
    v_max_f32 v33, s31, v33
    v_mfma_f32_16x16x32_bf16 v[100:103], v[60:63], v[84:87], v[100:103]
    v_exp_f32_e64 v42, v42 clamp
    v_max_f32 v34, s31, v34
    v_exp_f32_e64 v43, v43 clamp
    v_max_f32 v35, s31, v35
    s_cmp_eq_u32 s53, 0
    s_cbranch_scc1 standalone__linear_attn_elu__prompt_kernel_nz2
    v_mfma_f32_16x16x32_bf16 v[112:115], v[48:51], v[120:123], v[112:115]
    v_mfma_f32_16x16x32_bf16 v[116:119], v[52:55], v[120:123], v[116:119]
    v_mfma_f32_16x16x32_bf16 v[112:115], v[56:59], v[120:123], v[112:115]
    v_mfma_f32_16x16x32_bf16 v[116:119], v[60:63], v[120:123], v[116:119]
standalone__linear_attn_elu__prompt_kernel_nz2:
    v_add_f32 v28, v36, v28
    v_add_f32 v29, v37, v29
    v_add_f32 v30, v38, v30
    v_add_f32 v31, v39, v31
    v_add_f32 v32, v40, v32
    v_add_f32 v33, v41, v33
    v_add_f32 v34, v42, v34
    v_add_f32 v35, v43, v35
    v_cvt_pk_bf16_f32 v44, v28, v29
    v_cvt_pk_bf16_f32 v45, v30, v31
    v_cvt_pk_bf16_f32 v46, v32, v33
    v_cvt_pk_bf16_f32 v47, v34, v35
    ds_write_b64 v4, v[44:45] offset:24576
    ds_write_b64 v5, v[46:47] offset:24576
    s_waitcnt vmcnt(3)
    s_add_u32 m0, s55, 40960
    s_nop 0
    buffer_load_dwordx4 v3, s[12:15], s49 offen nt lds
    s_add_u32 s49, s49, 16384
    s_waitcnt lgkmcnt(0)
    s_barrier
    ds_read_b64_tr_b16 v[64:65], v6 offset:24576
    ds_read_b64_tr_b16 v[66:67], v6 offset:26624
    ds_read_b64_tr_b16 v[68:69], v7 offset:24576
    ds_read_b64_tr_b16 v[70:71], v7 offset:26624
    ds_read_b64_tr_b16 v[72:73], v6 offset:28672
    ds_read_b64_tr_b16 v[74:75], v6 offset:30720
    ds_read_b64_tr_b16 v[76:77], v7 offset:28672
    ds_read_b64_tr_b16 v[78:79], v7 offset:30720
    ds_read_b64_tr_b16 v[80:81], v8 offset:24576
    ds_read_b64_tr_b16 v[82:83], v8 offset:26624
    ds_read_b64_tr_b16 v[84:85], v8 offset:28672
    ds_read_b64_tr_b16 v[86:87], v8 offset:30720
    s_waitcnt vmcnt(3)
    v_lshlrev_b32 v28, 16, v16
    v_and_b32 v29, s32, v16
    v_lshlrev_b32 v30, 16, v17
    v_and_b32 v31, s32, v17
    v_lshlrev_b32 v32, 16, v18
    v_and_b32 v33, s32, v18
    v_lshlrev_b32 v34, 16, v19
    v_and_b32 v35, s32, v19
    buffer_load_dwordx4 v[16:19], v2, s[8:11], s48 offen nt
    s_add_u32 s48, s48, 16384
    v_mul_f32 v36, s30, v28
    v_mul_f32 v37, s30, v29
    v_mul_f32 v38, s30, v30
    v_mul_f32 v39, s30, v31
    v_mul_f32 v40, s30, v32
    v_mul_f32 v41, s30, v33
    v_mul_f32 v42, s30, v34
    v_mul_f32 v43, s30, v35
    s_waitcnt lgkmcnt(0)
    v_mfma_f32_16x16x32_bf16 v[96:99], v[64:67], v[80:83], v[96:99]
    v_exp_f32_e64 v36, v36 clamp
    v_max_f32 v28, s31, v28
    v_exp_f32_e64 v37, v37 clamp
    v_max_f32 v29, s31, v29
    v_mfma_f32_16x16x32_bf16 v[100:103], v[68:71], v[80:83], v[100:103]
    v_exp_f32_e64 v38, v38 clamp
    v_max_f32 v30, s31, v30
    v_exp_f32_e64 v39, v39 clamp
    v_max_f32 v31, s31, v31
    v_mfma_f32_16x16x32_bf16 v[96:99], v[72:75], v[84:87], v[96:99]
    v_exp_f32_e64 v40, v40 clamp
    v_max_f32 v32, s31, v32
    v_exp_f32_e64 v41, v41 clamp
    v_max_f32 v33, s31, v33
    v_mfma_f32_16x16x32_bf16 v[100:103], v[76:79], v[84:87], v[100:103]
    v_exp_f32_e64 v42, v42 clamp
    v_max_f32 v34, s31, v34
    v_exp_f32_e64 v43, v43 clamp
    v_max_f32 v35, s31, v35
    s_cmp_eq_u32 s53, 0
    s_cbranch_scc1 standalone__linear_attn_elu__prompt_kernel_nz3
    v_mfma_f32_16x16x32_bf16 v[112:115], v[64:67], v[120:123], v[112:115]
    v_mfma_f32_16x16x32_bf16 v[116:119], v[68:71], v[120:123], v[116:119]
    v_mfma_f32_16x16x32_bf16 v[112:115], v[72:75], v[120:123], v[112:115]
    v_mfma_f32_16x16x32_bf16 v[116:119], v[76:79], v[120:123], v[116:119]
standalone__linear_attn_elu__prompt_kernel_nz3:
    v_add_f32 v28, v36, v28
    v_add_f32 v29, v37, v29
    v_add_f32 v30, v38, v30
    v_add_f32 v31, v39, v31
    v_add_f32 v32, v40, v32
    v_add_f32 v33, v41, v33
    v_add_f32 v34, v42, v34
    v_add_f32 v35, v43, v35
    v_cvt_pk_bf16_f32 v44, v28, v29
    v_cvt_pk_bf16_f32 v45, v30, v31
    v_cvt_pk_bf16_f32 v46, v32, v33
    v_cvt_pk_bf16_f32 v47, v34, v35
    ds_write_b64 v4, v[44:45] offset:32768
    ds_write_b64 v5, v[46:47] offset:32768
    s_waitcnt vmcnt(3)
    s_add_u32 m0, s55, 49152
    s_nop 0
    buffer_load_dwordx4 v3, s[12:15], s49 offen nt lds
    s_add_u32 s49, s49, 16384
    s_waitcnt lgkmcnt(0)
    s_barrier
    ds_read_b64_tr_b16 v[140:141], v6 offset:32768
    ds_read_b64_tr_b16 v[142:143], v6 offset:34816
    ds_read_b64_tr_b16 v[144:145], v7 offset:32768
    ds_read_b64_tr_b16 v[146:147], v7 offset:34816
    ds_read_b64_tr_b16 v[148:149], v6 offset:36864
    ds_read_b64_tr_b16 v[150:151], v6 offset:38912
    ds_read_b64_tr_b16 v[152:153], v7 offset:36864
    ds_read_b64_tr_b16 v[154:155], v7 offset:38912
    ds_read_b64_tr_b16 v[80:81], v8 offset:32768
    ds_read_b64_tr_b16 v[82:83], v8 offset:34816
    ds_read_b64_tr_b16 v[84:85], v8 offset:36864
    ds_read_b64_tr_b16 v[86:87], v8 offset:38912
    v_not_b32 v130, v130
    s_cmp_lg_u32 s4, s7
    s_cbranch_scc1 standalone__linear_attn_elu__prompt_kernel_nopub
    s_mov_b64 exec, 1
    buffer_store_dwordx2 v[130:131], v11, s[24:27], s52 offen sc1
    s_mov_b64 exec, -1
standalone__linear_attn_elu__prompt_kernel_nopub:
    s_waitcnt vmcnt(3)
    v_lshlrev_b32 v28, 16, v20
    v_and_b32 v29, s32, v20
    v_lshlrev_b32 v30, 16, v21
    v_and_b32 v31, s32, v21
    v_lshlrev_b32 v32, 16, v22
    v_and_b32 v33, s32, v22
    v_lshlrev_b32 v34, 16, v23
    v_and_b32 v35, s32, v23
    buffer_load_dwordx4 v[20:23], v2, s[8:11], s48 offen nt
    v_mul_f32 v36, s30, v28
    v_mul_f32 v37, s30, v29
    v_mul_f32 v38, s30, v30
    v_mul_f32 v39, s30, v31
    v_mul_f32 v40, s30, v32
    v_mul_f32 v41, s30, v33
    v_mul_f32 v42, s30, v34
    v_mul_f32 v43, s30, v35
    s_waitcnt lgkmcnt(0)
    v_mfma_f32_16x16x32_bf16 v[96:99], v[140:143], v[80:83], v[96:99]
    v_exp_f32_e64 v36, v36 clamp
    v_max_f32 v28, s31, v28
    v_exp_f32_e64 v37, v37 clamp
    v_max_f32 v29, s31, v29
    v_mfma_f32_16x16x32_bf16 v[100:103], v[144:147], v[80:83], v[100:103]
    v_exp_f32_e64 v38, v38 clamp
    v_max_f32 v30, s31, v30
    v_exp_f32_e64 v39, v39 clamp
    v_max_f32 v31, s31, v31
    v_mfma_f32_16x16x32_bf16 v[96:99], v[148:151], v[84:87], v[96:99]
    v_exp_f32_e64 v40, v40 clamp
    v_max_f32 v32, s31, v32
    v_exp_f32_e64 v41, v41 clamp
    v_max_f32 v33, s31, v33
    v_mfma_f32_16x16x32_bf16 v[100:103], v[152:155], v[84:87], v[100:103]
    v_exp_f32_e64 v42, v42 clamp
    v_max_f32 v34, s31, v34
    v_exp_f32_e64 v43, v43 clamp
    v_max_f32 v35, s31, v35
    s_cmp_eq_u32 s53, 0
    s_cbranch_scc1 standalone__linear_attn_elu__prompt_kernel_nz4
    v_mfma_f32_16x16x32_bf16 v[112:115], v[140:143], v[120:123], v[112:115]
    v_mfma_f32_16x16x32_bf16 v[116:119], v[144:147], v[120:123], v[116:119]
    v_mfma_f32_16x16x32_bf16 v[112:115], v[148:151], v[120:123], v[112:115]
    v_mfma_f32_16x16x32_bf16 v[116:119], v[152:155], v[120:123], v[116:119]
standalone__linear_attn_elu__prompt_kernel_nz4:
    v_add_f32 v28, v36, v28
    v_add_f32 v29, v37, v29
    v_add_f32 v30, v38, v30
    v_add_f32 v31, v39, v31
    v_add_f32 v32, v40, v32
    v_add_f32 v33, v41, v33
    v_add_f32 v34, v42, v34
    v_add_f32 v35, v43, v35
    v_cvt_pk_bf16_f32 v44, v28, v29
    v_cvt_pk_bf16_f32 v45, v30, v31
    v_cvt_pk_bf16_f32 v46, v32, v33
    v_cvt_pk_bf16_f32 v47, v34, v35
    ds_write_b64 v4, v[44:45] offset:40960
    ds_write_b64 v5, v[46:47] offset:40960
    s_waitcnt vmcnt(3)
    s_add_u32 m0, s55, 57344
    s_nop 0
    buffer_load_dwordx4 v3, s[12:15], s49 offen nt lds
    s_waitcnt lgkmcnt(0)
    s_barrier
    ds_read_b64_tr_b16 v[156:157], v6 offset:40960
    ds_read_b64_tr_b16 v[158:159], v6 offset:43008
    ds_read_b64_tr_b16 v[160:161], v7 offset:40960
    ds_read_b64_tr_b16 v[162:163], v7 offset:43008
    ds_read_b64_tr_b16 v[164:165], v6 offset:45056
    ds_read_b64_tr_b16 v[166:167], v6 offset:47104
    ds_read_b64_tr_b16 v[168:169], v7 offset:45056
    ds_read_b64_tr_b16 v[170:171], v7 offset:47104
    ds_read_b64_tr_b16 v[80:81], v8 offset:40960
    ds_read_b64_tr_b16 v[82:83], v8 offset:43008
    ds_read_b64_tr_b16 v[84:85], v8 offset:45056
    ds_read_b64_tr_b16 v[86:87], v8 offset:47104
    s_waitcnt vmcnt(3)
    v_lshlrev_b32 v28, 16, v16
    v_and_b32 v29, s32, v16
    v_lshlrev_b32 v30, 16, v17
    v_and_b32 v31, s32, v17
    v_lshlrev_b32 v32, 16, v18
    v_and_b32 v33, s32, v18
    v_lshlrev_b32 v34, 16, v19
    v_and_b32 v35, s32, v19
    s_add_u32 m0, s55, 65536
    s_nop 0
    buffer_load_dwordx4 v3, s[12:15], s50 offen nt lds
    s_add_u32 s50, s50, 16384
    s_add_u32 m0, s55, 73728
    s_nop 0
    buffer_load_dwordx4 v3, s[12:15], s50 offen nt lds
    s_add_u32 s50, s50, 16384
    v_mul_f32 v36, s30, v28
    v_mul_f32 v37, s30, v29
    v_mul_f32 v38, s30, v30
    v_mul_f32 v39, s30, v31
    v_mul_f32 v40, s30, v32
    v_mul_f32 v41, s30, v33
    v_mul_f32 v42, s30, v34
    v_mul_f32 v43, s30, v35
    s_waitcnt lgkmcnt(0)
    v_mfma_f32_16x16x32_bf16 v[96:99], v[156:159], v[80:83], v[96:99]
    v_exp_f32_e64 v36, v36 clamp
    v_max_f32 v28, s31, v28
    v_exp_f32_e64 v37, v37 clamp
    v_max_f32 v29, s31, v29
    v_mfma_f32_16x16x32_bf16 v[100:103], v[160:163], v[80:83], v[100:103]
    v_exp_f32_e64 v38, v38 clamp
    v_max_f32 v30, s31, v30
    v_exp_f32_e64 v39, v39 clamp
    v_max_f32 v31, s31, v31
    v_mfma_f32_16x16x32_bf16 v[96:99], v[164:167], v[84:87], v[96:99]
    v_exp_f32_e64 v40, v40 clamp
    v_max_f32 v32, s31, v32
    v_exp_f32_e64 v41, v41 clamp
    v_max_f32 v33, s31, v33
    v_mfma_f32_16x16x32_bf16 v[100:103], v[168:171], v[84:87], v[100:103]
    v_exp_f32_e64 v42, v42 clamp
    v_max_f32 v34, s31, v34
    v_exp_f32_e64 v43, v43 clamp
    v_max_f32 v35, s31, v35
    s_cmp_eq_u32 s53, 0
    s_cbranch_scc1 standalone__linear_attn_elu__prompt_kernel_nz5
    v_mfma_f32_16x16x32_bf16 v[112:115], v[156:159], v[120:123], v[112:115]
    v_mfma_f32_16x16x32_bf16 v[116:119], v[160:163], v[120:123], v[116:119]
    v_mfma_f32_16x16x32_bf16 v[112:115], v[164:167], v[120:123], v[112:115]
    v_mfma_f32_16x16x32_bf16 v[116:119], v[168:171], v[120:123], v[116:119]
standalone__linear_attn_elu__prompt_kernel_nz5:
    v_add_f32 v28, v36, v28
    v_add_f32 v29, v37, v29
    v_add_f32 v30, v38, v30
    v_add_f32 v31, v39, v31
    v_add_f32 v32, v40, v32
    v_add_f32 v33, v41, v33
    v_add_f32 v34, v42, v34
    v_add_f32 v35, v43, v35
    v_cvt_pk_bf16_f32 v44, v28, v29
    v_cvt_pk_bf16_f32 v45, v30, v31
    v_cvt_pk_bf16_f32 v46, v32, v33
    v_cvt_pk_bf16_f32 v47, v34, v35
    ds_write_b64 v4, v[44:45] offset:49152
    ds_write_b64 v5, v[46:47] offset:49152
    s_waitcnt vmcnt(4)
    s_add_u32 m0, s55, 81920
    s_nop 0
    buffer_load_dwordx4 v3, s[12:15], s50 offen nt lds
    s_add_u32 s50, s50, 16384
    s_add_u32 m0, s55, 0
    s_nop 0
    buffer_load_dwordx4 v3, s[12:15], s50 offen nt lds
    s_add_u32 s50, s50, 16384
    s_waitcnt lgkmcnt(0)
    s_barrier
    ds_read_b64_tr_b16 v[172:173], v6 offset:49152
    ds_read_b64_tr_b16 v[174:175], v6 offset:51200
    ds_read_b64_tr_b16 v[176:177], v7 offset:49152
    ds_read_b64_tr_b16 v[178:179], v7 offset:51200
    ds_read_b64_tr_b16 v[180:181], v6 offset:53248
    ds_read_b64_tr_b16 v[182:183], v6 offset:55296
    ds_read_b64_tr_b16 v[184:185], v7 offset:53248
    ds_read_b64_tr_b16 v[186:187], v7 offset:55296
    ds_read_b64_tr_b16 v[80:81], v8 offset:49152
    ds_read_b64_tr_b16 v[82:83], v8 offset:51200
    ds_read_b64_tr_b16 v[84:85], v8 offset:53248
    ds_read_b64_tr_b16 v[86:87], v8 offset:55296
    s_waitcnt vmcnt(5)
    v_lshlrev_b32 v28, 16, v20
    v_and_b32 v29, s32, v20
    v_lshlrev_b32 v30, 16, v21
    v_and_b32 v31, s32, v21
    v_lshlrev_b32 v32, 16, v22
    v_and_b32 v33, s32, v22
    v_lshlrev_b32 v34, 16, v23
    v_and_b32 v35, s32, v23
    s_add_u32 m0, s55, 8192
    s_nop 0
    buffer_load_dwordx4 v3, s[12:15], s50 offen nt lds
    s_add_u32 s50, s50, 16384
    s_add_u32 m0, s55, 16384
    s_nop 0
    buffer_load_dwordx4 v3, s[12:15], s50 offen nt lds
    s_add_u32 s50, s50, 16384
    v_mul_f32 v36, s30, v28
    v_mul_f32 v37, s30, v29
    v_mul_f32 v38, s30, v30
    v_mul_f32 v39, s30, v31
    v_mul_f32 v40, s30, v32
    v_mul_f32 v41, s30, v33
    v_mul_f32 v42, s30, v34
    v_mul_f32 v43, s30, v35
    s_waitcnt lgkmcnt(0)
    v_mfma_f32_16x16x32_bf16 v[96:99], v[172:175], v[80:83], v[96:99]
    v_exp_f32_e64 v36, v36 clamp
    v_max_f32 v28, s31, v28
    v_exp_f32_e64 v37, v37 clamp
    v_max_f32 v29, s31, v29
    v_mfma_f32_16x16x32_bf16 v[100:103], v[176:179], v[80:83], v[100:103]
    v_exp_f32_e64 v38, v38 clamp
    v_max_f32 v30, s31, v30
    v_exp_f32_e64 v39, v39 clamp
    v_max_f32 v31, s31, v31
    v_mfma_f32_16x16x32_bf16 v[96:99], v[180:183], v[84:87], v[96:99]
    v_exp_f32_e64 v40, v40 clamp
    v_max_f32 v32, s31, v32
    v_exp_f32_e64 v41, v41 clamp
    v_max_f32 v33, s31, v33
    v_mfma_f32_16x16x32_bf16 v[100:103], v[184:187], v[84:87], v[100:103]
    v_exp_f32_e64 v42, v42 clamp
    v_max_f32 v34, s31, v34
    v_exp_f32_e64 v43, v43 clamp
    v_max_f32 v35, s31, v35
    s_cmp_eq_u32 s53, 0
    s_cbranch_scc1 standalone__linear_attn_elu__prompt_kernel_nz6
    v_mfma_f32_16x16x32_bf16 v[112:115], v[172:175], v[120:123], v[112:115]
    v_mfma_f32_16x16x32_bf16 v[116:119], v[176:179], v[120:123], v[116:119]
    v_mfma_f32_16x16x32_bf16 v[112:115], v[180:183], v[120:123], v[112:115]
    v_mfma_f32_16x16x32_bf16 v[116:119], v[184:187], v[120:123], v[116:119]
standalone__linear_attn_elu__prompt_kernel_nz6:
    v_add_f32 v28, v36, v28
    v_add_f32 v29, v37, v29
    v_add_f32 v30, v38, v30
    v_add_f32 v31, v39, v31
    v_add_f32 v32, v40, v32
    v_add_f32 v33, v41, v33
    v_add_f32 v34, v42, v34
    v_add_f32 v35, v43, v35
    v_cvt_pk_bf16_f32 v44, v28, v29
    v_cvt_pk_bf16_f32 v45, v30, v31
    v_cvt_pk_bf16_f32 v46, v32, v33
    v_cvt_pk_bf16_f32 v47, v34, v35
    ds_write_b64 v4, v[44:45] offset:57344
    ds_write_b64 v5, v[46:47] offset:57344
    s_waitcnt vmcnt(6)
    buffer_load_dwordx2 v[128:129], v11, s[24:27], s51 offen sc1
    s_add_u32 m0, s55, 24576
    s_nop 0
    buffer_load_dwordx4 v3, s[12:15], s50 offen nt lds
    s_add_u32 s50, s50, 16384
    s_waitcnt lgkmcnt(0)
    s_barrier
    ds_read_b64_tr_b16 v[188:189], v6 offset:57344
    ds_read_b64_tr_b16 v[190:191], v6 offset:59392
    ds_read_b64_tr_b16 v[192:193], v7 offset:57344
    ds_read_b64_tr_b16 v[194:195], v7 offset:59392
    ds_read_b64_tr_b16 v[196:197], v6 offset:61440
    ds_read_b64_tr_b16 v[198:199], v6 offset:63488
    ds_read_b64_tr_b16 v[200:201], v7 offset:61440
    ds_read_b64_tr_b16 v[202:203], v7 offset:63488
    ds_read_b64_tr_b16 v[80:81], v8 offset:57344
    ds_read_b64_tr_b16 v[82:83], v8 offset:59392
    ds_read_b64_tr_b16 v[84:85], v8 offset:61440
    ds_read_b64_tr_b16 v[86:87], v8 offset:63488
    s_waitcnt lgkmcnt(0)
    v_mfma_f32_16x16x32_bf16 v[96:99], v[188:191], v[80:83], v[96:99]
    v_mfma_f32_16x16x32_bf16 v[100:103], v[192:195], v[80:83], v[100:103]
    v_mfma_f32_16x16x32_bf16 v[96:99], v[196:199], v[84:87], v[96:99]
    v_mfma_f32_16x16x32_bf16 v[100:103], v[200:203], v[84:87], v[100:103]
    s_cmp_eq_u32 s53, 0
    s_cbranch_scc1 standalone__linear_attn_elu__prompt_kernel_nz7
    v_mfma_f32_16x16x32_bf16 v[112:115], v[188:191], v[120:123], v[112:115]
    v_mfma_f32_16x16x32_bf16 v[116:119], v[192:195], v[120:123], v[116:119]
    v_mfma_f32_16x16x32_bf16 v[112:115], v[196:199], v[120:123], v[112:115]
    v_mfma_f32_16x16x32_bf16 v[116:119], v[200:203], v[120:123], v[116:119]
standalone__linear_attn_elu__prompt_kernel_nz7:
    s_nop 5
    v_cvt_pk_bf16_f32 v96, v96, v97
    v_cvt_pk_bf16_f32 v97, v98, v99
    v_cvt_pk_bf16_f32 v98, v100, v101
    v_cvt_pk_bf16_f32 v99, v102, v103
    buffer_store_dwordx4 v[96:99], v136, s[96:99], s59 offen
    s_waitcnt vmcnt(7)
    s_add_u32 m0, s55, 32768
    s_nop 0
    buffer_load_dwordx4 v3, s[12:15], s50 offen nt lds
    s_waitcnt lgkmcnt(0)
    s_barrier
    ds_read_b64_tr_b16 v[88:89], v216 offset:32768
    ds_read_b64_tr_b16 v[90:91], v216 offset:34816
    ds_read_b64_tr_b16 v[92:93], v216 offset:36864
    ds_read_b64_tr_b16 v[94:95], v216 offset:38912
    ds_read_b64_tr_b16 v[80:81], v216 offset:40960
    ds_read_b64_tr_b16 v[82:83], v216 offset:43008
    ds_read_b64_tr_b16 v[84:85], v216 offset:45056
    ds_read_b64_tr_b16 v[86:87], v216 offset:47104
    s_waitcnt lgkmcnt(6)
    v_mfma_f32_16x16x32_bf16 v[104:107], v[224:227], v[88:91], 0
    v_mfma_f32_16x16x32_bf16 v[108:111], v[228:231], v[88:91], 0
    s_waitcnt lgkmcnt(4)
    v_mfma_f32_16x16x32_bf16 v[104:107], v[232:235], v[92:95], v[104:107]
    v_mfma_f32_16x16x32_bf16 v[108:111], v[236:239], v[92:95], v[108:111]
    s_add_u32 m0, s92, 0
    s_add_u32 s5, s3, 0
    buffer_load_dwordx4 v220, s[16:19], s5 offen nt lds
    s_waitcnt lgkmcnt(2)
    v_mfma_f32_16x16x32_bf16 v[104:107], v[240:243], v[80:83], v[104:107]
    v_mfma_f32_16x16x32_bf16 v[108:111], v[244:247], v[80:83], v[108:111]
    s_waitcnt lgkmcnt(0)
    v_mfma_f32_16x16x32_bf16 v[104:107], v[248:251], v[84:87], v[104:107]
    v_mfma_f32_16x16x32_bf16 v[108:111], v[252:255], v[84:87], v[108:111]
    s_waitcnt vmcnt(7)
    s_add_u32 m0, s92, 8192
    s_add_u32 s5, s3, 0
    buffer_load_dwordx4 v221, s[16:19], s5 offen nt lds
    s_waitcnt lgkmcnt(0)
    s_barrier
    ds_read_b64_tr_b16 v[88:89], v216 offset:49152
    ds_read_b64_tr_b16 v[90:91], v216 offset:51200
    ds_read_b64_tr_b16 v[92:93], v216 offset:53248
    ds_read_b64_tr_b16 v[94:95], v216 offset:55296
    ds_read_b64_tr_b16 v[80:81], v8 offset:0
    ds_read_b64_tr_b16 v[82:83], v8 offset:2048
    ds_read_b64_tr_b16 v[84:85], v8 offset:4096
    ds_read_b64_tr_b16 v[86:87], v8 offset:6144
    s_waitcnt lgkmcnt(6)
    v_mfma_f32_16x16x32_bf16 v[104:107], v[48:51], v[88:91], v[104:107]
    v_mfma_f32_16x16x32_bf16 v[108:111], v[52:55], v[88:91], v[108:111]
    s_waitcnt lgkmcnt(4)
    v_mfma_f32_16x16x32_bf16 v[104:107], v[56:59], v[92:95], v[104:107]
    v_mfma_f32_16x16x32_bf16 v[108:111], v[60:63], v[92:95], v[108:111]
    s_add_u32 m0, s92, 16384
    s_add_u32 s5, s3, 128
    buffer_load_dwordx4 v220, s[16:19], s5 offen nt lds
    s_waitcnt lgkmcnt(2)
    v_mfma_f32_16x16x32_bf16 v[104:107], v[64:67], v[80:83], v[104:107]
    v_mfma_f32_16x16x32_bf16 v[108:111], v[68:71], v[80:83], v[108:111]
    s_waitcnt lgkmcnt(0)
    v_mfma_f32_16x16x32_bf16 v[104:107], v[72:75], v[84:87], v[104:107]
    v_mfma_f32_16x16x32_bf16 v[108:111], v[76:79], v[84:87], v[108:111]
    s_waitcnt vmcnt(7)
    s_add_u32 m0, s92, 24576
    s_add_u32 s5, s3, 128
    buffer_load_dwordx4 v221, s[16:19], s5 offen nt lds
    s_waitcnt lgkmcnt(0)
    s_barrier
    ds_read_b64_tr_b16 v[88:89], v8 offset:8192
    ds_read_b64_tr_b16 v[90:91], v8 offset:10240
    ds_read_b64_tr_b16 v[92:93], v8 offset:12288
    ds_read_b64_tr_b16 v[94:95], v8 offset:14336
    ds_read_b64_tr_b16 v[80:81], v8 offset:16384
    ds_read_b64_tr_b16 v[82:83], v8 offset:18432
    ds_read_b64_tr_b16 v[84:85], v8 offset:20480
    ds_read_b64_tr_b16 v[86:87], v8 offset:22528
    s_waitcnt lgkmcnt(6)
    v_mfma_f32_16x16x32_bf16 v[104:107], v[140:143], v[88:91], v[104:107]
    v_mfma_f32_16x16x32_bf16 v[108:111], v[144:147], v[88:91], v[108:111]
    s_waitcnt lgkmcnt(4)
    v_mfma_f32_16x16x32_bf16 v[104:107], v[148:151], v[92:95], v[104:107]
    v_mfma_f32_16x16x32_bf16 v[108:111], v[152:155], v[92:95], v[108:111]
    s_waitcnt lgkmcnt(2)
    v_mfma_f32_16x16x32_bf16 v[104:107], v[156:159], v[80:83], v[104:107]
    v_mfma_f32_16x16x32_bf16 v[108:111], v[160:163], v[80:83], v[108:111]
    s_waitcnt lgkmcnt(0)
    v_mfma_f32_16x16x32_bf16 v[104:107], v[164:167], v[84:87], v[104:107]
    v_mfma_f32_16x16x32_bf16 v[108:111], v[168:171], v[84:87], v[108:111]
    s_waitcnt vmcnt(4)
    v_cmp_eq_u64 vcc, v[128:129], v[130:131]
    s_cbranch_vccz standalone__linear_attn_elu__prompt_kernel_fslow
standalone__linear_attn_elu__prompt_kernel_fok:
    s_waitcnt lgkmcnt(0)
    s_barrier
    ds_read_b32 v133, v132
    ds_read_b64_tr_b16 v[88:89], v8 offset:24576
    ds_read_b64_tr_b16 v[90:91], v8 offset:26624
    ds_read_b64_tr_b16 v[92:93], v8 offset:28672
    ds_read_b64_tr_b16 v[94:95], v8 offset:30720
    ds_read_b64_tr_b16 v[80:81], v8 offset:32768
    ds_read_b64_tr_b16 v[82:83], v8 offset:34816
    ds_read_b64_tr_b16 v[84:85], v8 offset:36864
    ds_read_b64_tr_b16 v[86:87], v8 offset:38912
    s_waitcnt lgkmcnt(6)
    v_mfma_f32_16x16x32_bf16 v[104:107], v[172:175], v[88:91], v[104:107]
    v_mfma_f32_16x16x32_bf16 v[108:111], v[176:179], v[88:91], v[108:111]
    s_waitcnt lgkmcnt(4)
    v_mfma_f32_16x16x32_bf16 v[104:107], v[180:183], v[92:95], v[104:107]
    v_mfma_f32_16x16x32_bf16 v[108:111], v[184:187], v[92:95], v[108:111]
    v_readfirstlane_b32 s94, v133
    s_cmp_eq_u32 s53, 0
    s_cbranch_scc1 standalone__linear_attn_elu__prompt_kernel_nzs
    v_lshlrev_b32 v14, 1, v1
    s_lshl_b32 s5, s57, 7
    s_add_u32 s5, s5, s52
    s_add_u32 s5, s5, 20971520
    v_min_u32 v112, -2, v112
    v_min_u32 v116, -2, v116
    s_mov_b32 exec_lo, 0x10001
    s_mov_b32 exec_hi, 0x10001
    buffer_store_dwordx4 v[112:115], v14, s[24:27], s5 offen
    buffer_store_dwordx4 v[116:119], v14, s[24:27], s5 offen offset:16
    s_mov_b64 exec, -1
standalone__linear_attn_elu__prompt_kernel_nzs:
    s_waitcnt lgkmcnt(2)
    v_mfma_f32_16x16x32_bf16 v[104:107], v[188:191], v[80:83], v[104:107]
    v_mfma_f32_16x16x32_bf16 v[108:111], v[192:195], v[80:83], v[108:111]
    s_waitcnt lgkmcnt(0)
    v_mfma_f32_16x16x32_bf16 v[104:107], v[196:199], v[84:87], v[104:107]
    v_mfma_f32_16x16x32_bf16 v[108:111], v[200:203], v[84:87], v[108:111]
    s_cmp_lg_u32 s94, 0
    s_cbranch_scc1 standalone__linear_attn_elu__prompt_kernel_fb1
    s_nop 4
    v_cvt_pk_bf16_f32 v100, v104, v105
    v_cvt_pk_bf16_f32 v101, v106, v107
    v_cvt_pk_bf16_f32 v102, v108, v109
    v_cvt_pk_bf16_f32 v103, v110, v111
    v_min_u32 v100, -2, v100
    s_not_b64 exec, s[60:61]
    buffer_store_dwordx4 v[100:103], v138, s[24:27], s62 offen
    s_mov_b64 exec, -1
standalone__linear_attn_elu__prompt_kernel_snd2:
    s_mov_b32 s100, 0
    v_and_b32 v13, 15, v1
    v_lshrrev_b32 v14, 4, v1
    v_lshrrev_b32 v12, 3, v13
    v_and_b32 v2, 1, v13
    v_lshlrev_b32 v15, 12, v12
    v_lshl_add_u32 v15, v2, 13, v15
    v_lshl_add_u32 v15, v14, 9, v15
    v_lshl_add_u32 v15, v2, 4, v15
    v_lshrrev_b32 v2, 2, v13
    v_lshl_add_u32 v15, v2, 5, v15
    v_bfe_u32 v2, v1, 1, 2
    v_lshl_add_u32 v15, v2, 7, v15
    v_add_u32 v84, 122880, v15
    v_mov_b32 v11, v218
    v_mov_b32 v12, v219
    v_xor_b32 v85, 16, v84
    v_xor_b32 v86, 32, v84
    v_xor_b32 v87, 48, v84
    v_xor_b32 v88, 64, v84
    v_xor_b32 v89, 80, v84
    v_xor_b32 v90, 96, v84
    v_xor_b32 v91, 112, v84
    v_lshlrev_b32 v2, 4, v13
    v_lshlrev_b32 v13, 4, v14
    v_add_u32 v13, 155648, v13
    v_lshl_add_u32 v14, v14, 10, v2
    s_lshl_b32 s55, s4, 12
    s_add_u32 s55, s55, 122880
    v_add_u32 v15, s55, v9
    s_lshl_b32 s51, s51, 5
    s_add_u32 s51, s51, 16777216
    buffer_load_dword v135, v134, s[24:27], s93 offen sc1 nt
    s_waitcnt vmcnt(5)
    s_waitcnt vmcnt(4)
    ds_read_b128 v[224:227], v11 offset:0
    ds_read_b128 v[228:231], v12 offset:0
    s_waitcnt lgkmcnt(0)
    v_lshlrev_b32 v28, 16, v224
    v_and_b32 v29, s32, v224
    v_lshlrev_b32 v30, 16, v225
    v_and_b32 v31, s32, v225
    v_lshlrev_b32 v32, 16, v226
    v_and_b32 v33, s32, v226
    v_lshlrev_b32 v34, 16, v227
    v_and_b32 v35, s32, v227
    v_pk_mul_f32 v[36:37], v[28:29], s[30:31] op_sel_hi:[1,0]
    v_pk_mul_f32 v[38:39], v[30:31], s[30:31] op_sel_hi:[1,0]
    v_pk_mul_f32 v[40:41], v[32:33], s[30:31] op_sel_hi:[1,0]
    v_pk_mul_f32 v[42:43], v[34:35], s[30:31] op_sel_hi:[1,0]
    v_exp_f32_e64 v36, v36 clamp
    v_max_f32 v28, s31, v28
    v_exp_f32_e64 v37, v37 clamp
    v_max_f32 v29, s31, v29
    v_exp_f32_e64 v38, v38 clamp
    v_max_f32 v30, s31, v30
    v_exp_f32_e64 v39, v39 clamp
    v_max_f32 v31, s31, v31
    v_exp_f32_e64 v40, v40 clamp
    v_max_f32 v32, s31, v32
    v_exp_f32_e64 v41, v41 clamp
    v_max_f32 v33, s31, v33
    v_exp_f32_e64 v42, v42 clamp
    v_max_f32 v34, s31, v34
    v_exp_f32_e64 v43, v43 clamp
    v_max_f32 v35, s31, v35
    v_pk_add_f32 v[28:29], v[36:37], v[28:29]
    v_pk_add_f32 v[30:31], v[38:39], v[30:31]
    v_pk_add_f32 v[32:33], v[40:41], v[32:33]
    v_pk_add_f32 v[34:35], v[42:43], v[34:35]
    v_cvt_pk_bf16_f32 v224, v28, v29
    v_cvt_pk_bf16_f32 v225, v30, v31
    v_cvt_pk_bf16_f32 v226, v32, v33
    v_cvt_pk_bf16_f32 v227, v34, v35
    v_lshlrev_b32 v28, 16, v228
    v_and_b32 v29, s32, v228
    v_lshlrev_b32 v30, 16, v229
    v_and_b32 v31, s32, v229
    v_lshlrev_b32 v32, 16, v230
    v_and_b32 v33, s32, v230
    v_lshlrev_b32 v34, 16, v231
    v_and_b32 v35, s32, v231
    v_pk_mul_f32 v[36:37], v[28:29], s[30:31] op_sel_hi:[1,0]
    v_pk_mul_f32 v[38:39], v[30:31], s[30:31] op_sel_hi:[1,0]
    v_pk_mul_f32 v[40:41], v[32:33], s[30:31] op_sel_hi:[1,0]
    v_pk_mul_f32 v[42:43], v[34:35], s[30:31] op_sel_hi:[1,0]
    v_exp_f32_e64 v36, v36 clamp
    v_max_f32 v28, s31, v28
    v_exp_f32_e64 v37, v37 clamp
    v_max_f32 v29, s31, v29
    v_exp_f32_e64 v38, v38 clamp
    v_max_f32 v30, s31, v30
    v_exp_f32_e64 v39, v39 clamp
    v_max_f32 v31, s31, v31
    v_exp_f32_e64 v40, v40 clamp
    v_max_f32 v32, s31, v32
    v_exp_f32_e64 v41, v41 clamp
    v_max_f32 v33, s31, v33
    v_exp_f32_e64 v42, v42 clamp
    v_max_f32 v34, s31, v34
    v_exp_f32_e64 v43, v43 clamp
    v_max_f32 v35, s31, v35
    v_pk_add_f32 v[28:29], v[36:37], v[28:29]
    v_pk_add_f32 v[30:31], v[38:39], v[30:31]
    v_pk_add_f32 v[32:33], v[40:41], v[32:33]
    v_pk_add_f32 v[34:35], v[42:43], v[34:35]
    v_cvt_pk_bf16_f32 v228, v28, v29
    v_cvt_pk_bf16_f32 v229, v30, v31
    v_cvt_pk_bf16_f32 v230, v32, v33
    v_cvt_pk_bf16_f32 v231, v34, v35
    s_waitcnt vmcnt(0)
standalone__linear_attn_elu__prompt_kernel_ce_c:
    v_cmp_eq_u32 vcc, -1, v135
    s_cbranch_vccnz standalone__linear_attn_elu__prompt_kernel_ce_r
standalone__linear_attn_elu__prompt_kernel_ce_ok:
    buffer_load_dwordx4 v[140:143], v137, s[96:99], 0 offen nt
    s_cmp_lg_u32 s4, 7
    s_cbranch_scc1 standalone__linear_attn_elu__prompt_kernel_z0
    v_bfe_u32 v64, v1, 4, 1
    v_and_b32 v65, 0xf0, v9
    v_lshl_add_u32 v64, v64, 10, v65
    s_add_u32 s6, s56, 20971520
    buffer_load_dwordx4 v[48:51], v64, s[24:27], s6 offen offset:0 sc1 nt
    buffer_load_dwordx4 v[52:55], v64, s[24:27], s6 offen offset:256 sc1 nt
    buffer_load_dwordx4 v[56:59], v64, s[24:27], s6 offen offset:512 sc1 nt
    buffer_load_dwordx4 v[60:63], v64, s[24:27], s6 offen offset:768 sc1 nt
standalone__linear_attn_elu__prompt_kernel_z0:
    buffer_load_dwordx4 v[156:159], v138, s[24:27], s95 offen sc1 nt
    s_barrier
    s_and_b32 s5, s100, 1
    s_cbranch_scc1 standalone__linear_attn_elu__prompt_kernel_sk1
    s_add_u32 m0, s92, 32768
    s_add_u32 s5, s3, 4096
    buffer_load_dwordx4 v220, s[16:19], s5 offen nt lds
    s_add_u32 m0, s92, 40960
    s_add_u32 s5, s3, 4096
    buffer_load_dwordx4 v221, s[16:19], s5 offen nt lds
    s_branch standalone__linear_attn_elu__prompt_kernel_sk1x
standalone__linear_attn_elu__prompt_kernel_sk1:
    s_waitcnt vmcnt(0)
standalone__linear_attn_elu__prompt_kernel_sk1x:
    s_add_u32 m0, s92, 49152
    s_add_u32 s5, s3, 4224
    buffer_load_dwordx4 v220, s[16:19], s5 offen nt lds
    s_add_u32 m0, s92, 57344
    s_add_u32 s5, s3, 4224
    buffer_load_dwordx4 v221, s[16:19], s5 offen nt lds
    s_and_b32 s5, s100, 1
    s_cbranch_scc1 standalone__linear_attn_elu__prompt_kernel_sk3
    ds_read_b128 v[232:235], v11 offset:16384
    ds_read_b128 v[236:239], v12 offset:16384
    s_waitcnt lgkmcnt(0)
    v_lshlrev_b32 v28, 16, v232
    v_and_b32 v29, s32, v232
    v_lshlrev_b32 v30, 16, v233
    v_and_b32 v31, s32, v233
    v_lshlrev_b32 v32, 16, v234
    v_and_b32 v33, s32, v234
    v_lshlrev_b32 v34, 16, v235
    v_and_b32 v35, s32, v235
    v_pk_mul_f32 v[36:37], v[28:29], s[30:31] op_sel_hi:[1,0]
    v_pk_mul_f32 v[38:39], v[30:31], s[30:31] op_sel_hi:[1,0]
    v_pk_mul_f32 v[40:41], v[32:33], s[30:31] op_sel_hi:[1,0]
    v_pk_mul_f32 v[42:43], v[34:35], s[30:31] op_sel_hi:[1,0]
    v_exp_f32_e64 v36, v36 clamp
    v_max_f32 v28, s31, v28
    v_exp_f32_e64 v37, v37 clamp
    v_max_f32 v29, s31, v29
    v_exp_f32_e64 v38, v38 clamp
    v_max_f32 v30, s31, v30
    v_exp_f32_e64 v39, v39 clamp
    v_max_f32 v31, s31, v31
    v_exp_f32_e64 v40, v40 clamp
    v_max_f32 v32, s31, v32
    v_exp_f32_e64 v41, v41 clamp
    v_max_f32 v33, s31, v33
    v_exp_f32_e64 v42, v42 clamp
    v_max_f32 v34, s31, v34
    v_exp_f32_e64 v43, v43 clamp
    v_max_f32 v35, s31, v35
    v_pk_add_f32 v[28:29], v[36:37], v[28:29]
    v_pk_add_f32 v[30:31], v[38:39], v[30:31]
    v_pk_add_f32 v[32:33], v[40:41], v[32:33]
    v_pk_add_f32 v[34:35], v[42:43], v[34:35]
    v_cvt_pk_bf16_f32 v232, v28, v29
    v_cvt_pk_bf16_f32 v233, v30, v31
    v_cvt_pk_bf16_f32 v234, v32, v33
    v_cvt_pk_bf16_f32 v235, v34, v35
    v_lshlrev_b32 v28, 16, v236
    v_and_b32 v29, s32, v236
    v_lshlrev_b32 v30, 16, v237
    v_and_b32 v31, s32, v237
    v_lshlrev_b32 v32, 16, v238
    v_and_b32 v33, s32, v238
    v_lshlrev_b32 v34, 16, v239
    v_and_b32 v35, s32, v239
    v_pk_mul_f32 v[36:37], v[28:29], s[30:31] op_sel_hi:[1,0]
    v_pk_mul_f32 v[38:39], v[30:31], s[30:31] op_sel_hi:[1,0]
    v_pk_mul_f32 v[40:41], v[32:33], s[30:31] op_sel_hi:[1,0]
    v_pk_mul_f32 v[42:43], v[34:35], s[30:31] op_sel_hi:[1,0]
    v_exp_f32_e64 v36, v36 clamp
    v_max_f32 v28, s31, v28
    v_exp_f32_e64 v37, v37 clamp
    v_max_f32 v29, s31, v29
    v_exp_f32_e64 v38, v38 clamp
    v_max_f32 v30, s31, v30
    v_exp_f32_e64 v39, v39 clamp
    v_max_f32 v31, s31, v31
    v_exp_f32_e64 v40, v40 clamp
    v_max_f32 v32, s31, v32
    v_exp_f32_e64 v41, v41 clamp
    v_max_f32 v33, s31, v33
    v_exp_f32_e64 v42, v42 clamp
    v_max_f32 v34, s31, v34
    v_exp_f32_e64 v43, v43 clamp
    v_max_f32 v35, s31, v35
    v_pk_add_f32 v[28:29], v[36:37], v[28:29]
    v_pk_add_f32 v[30:31], v[38:39], v[30:31]
    v_pk_add_f32 v[32:33], v[40:41], v[32:33]
    v_pk_add_f32 v[34:35], v[42:43], v[34:35]
    v_cvt_pk_bf16_f32 v236, v28, v29
    v_cvt_pk_bf16_f32 v237, v30, v31
    v_cvt_pk_bf16_f32 v238, v32, v33
    v_cvt_pk_bf16_f32 v239, v34, v35
standalone__linear_attn_elu__prompt_kernel_sk3:
    s_waitcnt vmcnt(5)
    v_lshlrev_b32 v148, 16, v140
    v_and_b32 v149, s32, v140
    v_lshlrev_b32 v150, 16, v141
    v_and_b32 v151, s32, v141
    v_lshlrev_b32 v152, 16, v142
    v_and_b32 v153, s32, v142
    v_lshlrev_b32 v154, 16, v143
    v_and_b32 v155, s32, v143
    v_add_f32 v104, v104, v148
    v_add_f32 v105, v105, v149
    v_add_f32 v106, v106, v150
    v_add_f32 v107, v107, v151
    v_add_f32 v108, v108, v152
    v_add_f32 v109, v109, v153
    v_add_f32 v110, v110, v154
    v_add_f32 v111, v111, v155
    v_add_f32_dpp v104, v148, v104 row_ror:8 row_mask:0xf bank_mask:0xf
    v_add_f32_dpp v105, v149, v105 row_ror:8 row_mask:0xf bank_mask:0xf
    v_add_f32_dpp v106, v150, v106 row_ror:8 row_mask:0xf bank_mask:0xf
    v_add_f32_dpp v107, v151, v107 row_ror:8 row_mask:0xf bank_mask:0xf
    v_add_f32_dpp v108, v152, v108 row_ror:8 row_mask:0xf bank_mask:0xf
    v_add_f32_dpp v109, v153, v109 row_ror:8 row_mask:0xf bank_mask:0xf
    v_add_f32_dpp v110, v154, v110 row_ror:8 row_mask:0xf bank_mask:0xf
    v_add_f32_dpp v111, v155, v111 row_ror:8 row_mask:0xf bank_mask:0xf
    s_waitcnt vmcnt(4)
standalone__linear_attn_elu__prompt_kernel_fin_c:
    v_cmp_eq_u32 vcc, -1, v156
    s_cbranch_vccnz standalone__linear_attn_elu__prompt_kernel_fin_r
standalone__linear_attn_elu__prompt_kernel_fin_ok:
    v_lshlrev_b32 v148, 16, v156
    v_and_b32 v149, s32, v156
    v_lshlrev_b32 v150, 16, v157
    v_and_b32 v151, s32, v157
    v_lshlrev_b32 v152, 16, v158
    v_and_b32 v153, s32, v158
    v_lshlrev_b32 v154, 16, v159
    v_and_b32 v155, s32, v159
    v_add_f32 v104, v104, v148
    v_add_f32 v105, v105, v149
    v_add_f32 v106, v106, v150
    v_add_f32 v107, v107, v151
    v_add_f32 v108, v108, v152
    v_add_f32 v109, v109, v153
    v_add_f32 v110, v110, v154
    v_add_f32 v111, v111, v155
    v_cvt_pk_bf16_f32 v76, v104, v105
    v_cvt_pk_bf16_f32 v77, v106, v107
    v_cvt_pk_bf16_f32 v78, v108, v109
    v_cvt_pk_bf16_f32 v79, v110, v111
    v_min_u32 v76, -2, v76
    s_mov_b64 exec, s[60:61]
    s_cmp_lg_u32 s94, 0
    s_cbranch_scc1 standalone__linear_attn_elu__prompt_kernel_fsc
    buffer_store_dwordx4 v[76:79], v10, s[24:27], s63 offen
standalone__linear_attn_elu__prompt_kernel_fsc_x:
    s_mov_b64 exec, -1
    s_cmp_lg_u32 s4, 7
    s_cbranch_scc1 standalone__linear_attn_elu__prompt_kernel_z1
standalone__linear_attn_elu__prompt_kernel_zz_c:
    v_max3_u32 v72, v48, v52, v56
    v_max_u32 v72, v72, v60
    v_cmp_eq_u32 vcc, -1, v72
    s_cbranch_vccnz standalone__linear_attn_elu__prompt_kernel_zz_r
standalone__linear_attn_elu__prompt_kernel_zz_ok:
    v_add_f32 v48, v48, v52
    v_add_f32 v49, v49, v53
    v_add_f32 v50, v50, v54
    v_add_f32 v51, v51, v55
    v_add_f32 v56, v56, v60
    v_add_f32 v57, v57, v61
    v_add_f32 v58, v58, v62
    v_add_f32 v59, v59, v63
    v_add_f32 v48, v48, v56
    v_add_f32 v49, v49, v57
    v_add_f32 v50, v50, v58
    v_add_f32 v51, v51, v59
    v_cvt_pk_bf16_f32 v48, v48, v49
    v_cvt_pk_bf16_f32 v49, v50, v51
    v_and_b32 v65, 31, v1
    v_lshlrev_b32 v65, 3, v65
    v_add_u32 v65, 155648, v65
    ds_write_b64 v65, v[48:49]
standalone__linear_attn_elu__prompt_kernel_z1:
    s_and_b32 s5, s100, 2
    s_cbranch_scc1 standalone__linear_attn_elu__prompt_kernel_sk5
    s_waitcnt vmcnt(4)
    s_waitcnt vmcnt(3)
    ds_read_b128 v[240:243], v11 offset:32768
    ds_read_b128 v[244:247], v12 offset:32768
    s_waitcnt lgkmcnt(0)
    v_lshlrev_b32 v28, 16, v240
    v_and_b32 v29, s32, v240
    v_lshlrev_b32 v30, 16, v241
    v_and_b32 v31, s32, v241
    v_lshlrev_b32 v32, 16, v242
    v_and_b32 v33, s32, v242
    v_lshlrev_b32 v34, 16, v243
    v_and_b32 v35, s32, v243
    v_pk_mul_f32 v[36:37], v[28:29], s[30:31] op_sel_hi:[1,0]
    v_pk_mul_f32 v[38:39], v[30:31], s[30:31] op_sel_hi:[1,0]
    v_pk_mul_f32 v[40:41], v[32:33], s[30:31] op_sel_hi:[1,0]
    v_pk_mul_f32 v[42:43], v[34:35], s[30:31] op_sel_hi:[1,0]
    v_exp_f32_e64 v36, v36 clamp
    v_max_f32 v28, s31, v28
    v_exp_f32_e64 v37, v37 clamp
    v_max_f32 v29, s31, v29
    v_exp_f32_e64 v38, v38 clamp
    v_max_f32 v30, s31, v30
    v_exp_f32_e64 v39, v39 clamp
    v_max_f32 v31, s31, v31
    v_exp_f32_e64 v40, v40 clamp
    v_max_f32 v32, s31, v32
    v_exp_f32_e64 v41, v41 clamp
    v_max_f32 v33, s31, v33
    v_exp_f32_e64 v42, v42 clamp
    v_max_f32 v34, s31, v34
    v_exp_f32_e64 v43, v43 clamp
    v_max_f32 v35, s31, v35
    v_pk_add_f32 v[28:29], v[36:37], v[28:29]
    v_pk_add_f32 v[30:31], v[38:39], v[30:31]
    v_pk_add_f32 v[32:33], v[40:41], v[32:33]
    v_pk_add_f32 v[34:35], v[42:43], v[34:35]
    v_cvt_pk_bf16_f32 v240, v28, v29
    v_cvt_pk_bf16_f32 v241, v30, v31
    v_cvt_pk_bf16_f32 v242, v32, v33
    v_cvt_pk_bf16_f32 v243, v34, v35
standalone__linear_attn_elu__prompt_kernel_sk5:
    s_cmp_lg_u32 s94, 0
    s_cbranch_scc1 standalone__linear_attn_elu__prompt_kernel_gb2o
standalone__linear_attn_elu__prompt_kernel_gb2o_x:
    s_mov_b32 m0, s55
    s_nop 0
    buffer_load_dwordx4 v9, s[24:27], s51 offen offset:0 sc1 nt lds
    buffer_load_dwordx4 v9, s[24:27], s51 offen offset:1024 sc1 nt lds
    buffer_load_dwordx4 v9, s[24:27], s51 offen offset:2048 sc1 nt lds
    buffer_load_dwordx4 v9, s[24:27], s51 offen offset:3072 sc1 nt lds
    s_and_b32 s5, s100, 2
    s_cbranch_scc1 standalone__linear_attn_elu__prompt_kernel_sk7
    v_lshlrev_b32 v28, 16, v244
    v_and_b32 v29, s32, v244
    v_lshlrev_b32 v30, 16, v245
    v_and_b32 v31, s32, v245
    v_lshlrev_b32 v32, 16, v246
    v_and_b32 v33, s32, v246
    v_lshlrev_b32 v34, 16, v247
    v_and_b32 v35, s32, v247
    v_pk_mul_f32 v[36:37], v[28:29], s[30:31] op_sel_hi:[1,0]
    v_pk_mul_f32 v[38:39], v[30:31], s[30:31] op_sel_hi:[1,0]
    v_pk_mul_f32 v[40:41], v[32:33], s[30:31] op_sel_hi:[1,0]
    v_pk_mul_f32 v[42:43], v[34:35], s[30:31] op_sel_hi:[1,0]
    v_exp_f32_e64 v36, v36 clamp
    v_max_f32 v28, s31, v28
    v_exp_f32_e64 v37, v37 clamp
    v_max_f32 v29, s31, v29
    v_exp_f32_e64 v38, v38 clamp
    v_max_f32 v30, s31, v30
    v_exp_f32_e64 v39, v39 clamp
    v_max_f32 v31, s31, v31
    v_exp_f32_e64 v40, v40 clamp
    v_max_f32 v32, s31, v32
    v_exp_f32_e64 v41, v41 clamp
    v_max_f32 v33, s31, v33
    v_exp_f32_e64 v42, v42 clamp
    v_max_f32 v34, s31, v34
    v_exp_f32_e64 v43, v43 clamp
    v_max_f32 v35, s31, v35
    v_pk_add_f32 v[28:29], v[36:37], v[28:29]
    v_pk_add_f32 v[30:31], v[38:39], v[30:31]
    v_pk_add_f32 v[32:33], v[40:41], v[32:33]
    v_pk_add_f32 v[34:35], v[42:43], v[34:35]
    v_cvt_pk_bf16_f32 v244, v28, v29
    v_cvt_pk_bf16_f32 v245, v30, v31
    v_cvt_pk_bf16_f32 v246, v32, v33
    v_cvt_pk_bf16_f32 v247, v34, v35
standalone__linear_attn_elu__prompt_kernel_sk7:
    s_waitcnt vmcnt(6)
    s_waitcnt vmcnt(5)
    ds_read_b128 v[248:251], v11 offset:49152
    ds_read_b128 v[252:255], v12 offset:49152
    s_waitcnt lgkmcnt(0)
    v_lshlrev_b32 v28, 16, v248
    v_and_b32 v29, s32, v248
    v_lshlrev_b32 v30, 16, v249
    v_and_b32 v31, s32, v249
    v_lshlrev_b32 v32, 16, v250
    v_and_b32 v33, s32, v250
    v_lshlrev_b32 v34, 16, v251
    v_and_b32 v35, s32, v251
    v_pk_mul_f32 v[36:37], v[28:29], s[30:31] op_sel_hi:[1,0]
    v_pk_mul_f32 v[38:39], v[30:31], s[30:31] op_sel_hi:[1,0]
    v_pk_mul_f32 v[40:41], v[32:33], s[30:31] op_sel_hi:[1,0]
    v_pk_mul_f32 v[42:43], v[34:35], s[30:31] op_sel_hi:[1,0]
    v_exp_f32_e64 v36, v36 clamp
    v_max_f32 v28, s31, v28
    v_exp_f32_e64 v37, v37 clamp
    v_max_f32 v29, s31, v29
    v_exp_f32_e64 v38, v38 clamp
    v_max_f32 v30, s31, v30
    v_exp_f32_e64 v39, v39 clamp
    v_max_f32 v31, s31, v31
    v_exp_f32_e64 v40, v40 clamp
    v_max_f32 v32, s31, v32
    v_exp_f32_e64 v41, v41 clamp
    v_max_f32 v33, s31, v33
    v_exp_f32_e64 v42, v42 clamp
    v_max_f32 v34, s31, v34
    v_exp_f32_e64 v43, v43 clamp
    v_max_f32 v35, s31, v35
    v_pk_add_f32 v[28:29], v[36:37], v[28:29]
    v_pk_add_f32 v[30:31], v[38:39], v[30:31]
    v_pk_add_f32 v[32:33], v[40:41], v[32:33]
    v_pk_add_f32 v[34:35], v[42:43], v[34:35]
    v_cvt_pk_bf16_f32 v248, v28, v29
    v_cvt_pk_bf16_f32 v249, v30, v31
    v_cvt_pk_bf16_f32 v250, v32, v33
    v_cvt_pk_bf16_f32 v251, v34, v35
    v_lshlrev_b32 v28, 16, v252
    v_and_b32 v29, s32, v252
    v_lshlrev_b32 v30, 16, v253
    v_and_b32 v31, s32, v253
    v_lshlrev_b32 v32, 16, v254
    v_and_b32 v33, s32, v254
    v_lshlrev_b32 v34, 16, v255
    v_and_b32 v35, s32, v255
    v_pk_mul_f32 v[36:37], v[28:29], s[30:31] op_sel_hi:[1,0]
    v_pk_mul_f32 v[38:39], v[30:31], s[30:31] op_sel_hi:[1,0]
    v_pk_mul_f32 v[40:41], v[32:33], s[30:31] op_sel_hi:[1,0]
    v_pk_mul_f32 v[42:43], v[34:35], s[30:31] op_sel_hi:[1,0]
    v_exp_f32_e64 v36, v36 clamp
    v_max_f32 v28, s31, v28
    v_exp_f32_e64 v37, v37 clamp
    v_max_f32 v29, s31, v29
    v_exp_f32_e64 v38, v38 clamp
    v_max_f32 v30, s31, v30
    v_exp_f32_e64 v39, v39 clamp
    v_max_f32 v31, s31, v31
    v_exp_f32_e64 v40, v40 clamp
    v_max_f32 v32, s31, v32
    v_exp_f32_e64 v41, v41 clamp
    v_max_f32 v33, s31, v33
    v_exp_f32_e64 v42, v42 clamp
    v_max_f32 v34, s31, v34
    v_exp_f32_e64 v43, v43 clamp
    v_max_f32 v35, s31, v35
    v_pk_add_f32 v[28:29], v[36:37], v[28:29]
    v_pk_add_f32 v[30:31], v[38:39], v[30:31]
    v_pk_add_f32 v[32:33], v[40:41], v[32:33]
    v_pk_add_f32 v[34:35], v[42:43], v[34:35]
    v_cvt_pk_bf16_f32 v252, v28, v29
    v_cvt_pk_bf16_f32 v253, v30, v31
    v_cvt_pk_bf16_f32 v254, v32, v33
    v_cvt_pk_bf16_f32 v255, v34, v35
    s_waitcnt vmcnt(0)
standalone__linear_attn_elu__prompt_kernel_go_c:
    ds_read_b32 v72, v15 offset:0
    ds_read_b32 v73, v15 offset:1024
    ds_read_b32 v74, v15 offset:2048
    ds_read_b32 v75, v15 offset:3072
    s_waitcnt lgkmcnt(0)
    v_max3_u32 v72, v72, v73, v74
    v_max_u32 v72, v72, v75
    v_cmp_eq_u32 vcc, -1, v72
    s_cbranch_vccnz standalone__linear_attn_elu__prompt_kernel_go_r
standalone__linear_attn_elu__prompt_kernel_go_ok:
    s_barrier
    ds_read_b128 v[16:19], v13 offset:0
    ds_read_b128 v[20:23], v13 offset:64
    ds_read_b128 v[24:27], v13 offset:128
    ds_read_b128 v[44:47], v13 offset:192
    ds_read_b128 v[96:99], v84 offset:0
    ds_read_b128 v[100:103], v85 offset:0
    ds_read_b128 v[104:107], v84 offset:2048
    ds_read_b128 v[108:111], v85 offset:2048
    ds_read_b128 v[112:115], v84 offset:16384
    ds_read_b128 v[116:119], v85 offset:16384
    ds_read_b128 v[120:123], v84 offset:18432
    ds_read_b128 v[124:127], v85 offset:18432
    ds_read_b128 v[128:131], v86 offset:0
    ds_read_b128 v[132:135], v87 offset:0
    ds_read_b128 v[136:139], v86 offset:2048
    s_waitcnt lgkmcnt(11)
    v_mfma_f32_16x16x32_bf16 v[80:83], v[224:227], v[16:19], 0
    v_mfma_f32_16x16x32_bf16 v[80:83], v[228:231], v[20:23], v[80:83]
    v_mfma_f32_16x16x32_bf16 v[80:83], v[232:235], v[24:27], v[80:83]
    v_mfma_f32_16x16x32_bf16 v[80:83], v[236:239], v[44:47], v[80:83]
    s_waitcnt lgkmcnt(10)
    v_mfma_f32_16x16x32_bf16 v[48:51], v[224:227], v[96:99], 0
    ds_read_b128 v[140:143], v87 offset:2048
    s_waitcnt lgkmcnt(10)
    v_mfma_f32_16x16x32_bf16 v[52:55], v[224:227], v[100:103], 0
    ds_read_b128 v[144:147], v86 offset:16384
    s_waitcnt lgkmcnt(10)
    v_mfma_f32_16x16x32_bf16 v[48:51], v[228:231], v[104:107], v[48:51]
    ds_read_b128 v[148:151], v87 offset:16384
    v_add_f32 v80, s31, v80
    v_add_f32 v81, s31, v81
    s_waitcnt lgkmcnt(10)
    v_mfma_f32_16x16x32_bf16 v[52:55], v[228:231], v[108:111], v[52:55]
    ds_read_b128 v[152:155], v86 offset:18432
    v_add_f32 v82, s31, v82
    v_add_f32 v83, s31, v83
    s_waitcnt lgkmcnt(10)
    v_mfma_f32_16x16x32_bf16 v[48:51], v[232:235], v[112:115], v[48:51]
    ds_read_b128 v[156:159], v87 offset:18432
    v_cvt_pk_bf16_f32 v80, v80, v81
    v_cvt_pk_bf16_f32 v82, v82, v83
    s_waitcnt lgkmcnt(10)
    v_mfma_f32_16x16x32_bf16 v[52:55], v[232:235], v[116:119], v[52:55]
    ds_read_b128 v[160:163], v88 offset:0
    v_and_b32 v81, s32, v80
    v_and_b32 v83, s32, v82
    s_waitcnt lgkmcnt(10)
    v_mfma_f32_16x16x32_bf16 v[48:51], v[236:239], v[120:123], v[48:51]
    ds_read_b128 v[164:167], v89 offset:0
    v_lshlrev_b32 v80, 16, v80
    v_lshlrev_b32 v82, 16, v82
    s_waitcnt lgkmcnt(10)
    v_mfma_f32_16x16x32_bf16 v[52:55], v[236:239], v[124:127], v[52:55]
    ds_read_b128 v[168:171], v88 offset:2048
    v_rcp_f32 v80, v80
    s_waitcnt lgkmcnt(10)
    v_mfma_f32_16x16x32_bf16 v[56:59], v[224:227], v[128:131], 0
    ds_read_b128 v[172:175], v89 offset:2048
    v_rcp_f32 v81, v81
    s_waitcnt lgkmcnt(10)
    v_mfma_f32_16x16x32_bf16 v[60:63], v[224:227], v[132:135], 0
    ds_read_b128 v[176:179], v88 offset:16384
    v_rcp_f32 v82, v82
    s_waitcnt lgkmcnt(10)
    v_mfma_f32_16x16x32_bf16 v[56:59], v[228:231], v[136:139], v[56:59]
    ds_read_b128 v[180:183], v89 offset:16384
    v_rcp_f32 v83, v83
    s_waitcnt lgkmcnt(10)
    v_mfma_f32_16x16x32_bf16 v[60:63], v[228:231], v[140:143], v[60:63]
    ds_read_b128 v[184:187], v88 offset:18432
    v_mul_f32 v48, v48, v80
    v_mul_f32 v52, v52, v80
    s_waitcnt lgkmcnt(10)
    v_mfma_f32_16x16x32_bf16 v[56:59], v[232:235], v[144:147], v[56:59]
    ds_read_b128 v[188:191], v89 offset:18432
    v_cvt_pk_bf16_f32 v28, v48, v52
    v_mul_f32 v49, v49, v81
    s_waitcnt lgkmcnt(10)
    v_mfma_f32_16x16x32_bf16 v[60:63], v[232:235], v[148:151], v[60:63]
    ds_read_b128 v[192:195], v90 offset:0
    v_mul_f32 v53, v53, v81
    v_cvt_pk_bf16_f32 v32, v49, v53
    s_waitcnt lgkmcnt(10)
    v_mfma_f32_16x16x32_bf16 v[56:59], v[236:239], v[152:155], v[56:59]
    ds_read_b128 v[196:199], v91 offset:0
    v_mul_f32 v50, v50, v82
    v_mul_f32 v54, v54, v82
    s_waitcnt lgkmcnt(10)
    v_mfma_f32_16x16x32_bf16 v[60:63], v[236:239], v[156:159], v[60:63]
    ds_read_b128 v[200:203], v90 offset:2048
    v_cvt_pk_bf16_f32 v36, v50, v54
    v_mul_f32 v51, v51, v83
    s_waitcnt lgkmcnt(10)
    v_mfma_f32_16x16x32_bf16 v[64:67], v[224:227], v[160:163], 0
    ds_read_b128 v[204:207], v91 offset:2048
    v_mul_f32 v55, v55, v83
    v_cvt_pk_bf16_f32 v40, v51, v55
    s_waitcnt lgkmcnt(10)
    v_mfma_f32_16x16x32_bf16 v[68:71], v[224:227], v[164:167], 0
    ds_read_b128 v[208:211], v90 offset:16384
    v_mul_f32 v56, v56, v80
    v_mul_f32 v60, v60, v80
    s_waitcnt lgkmcnt(10)
    v_mfma_f32_16x16x32_bf16 v[64:67], v[228:231], v[168:171], v[64:67]
    ds_read_b128 v[212:215], v91 offset:16384
    v_cvt_pk_bf16_f32 v29, v56, v60
    v_mul_f32 v57, v57, v81
    s_waitcnt lgkmcnt(10)
    v_mfma_f32_16x16x32_bf16 v[68:71], v[228:231], v[172:175], v[68:71]
    ds_read_b128 v[216:219], v90 offset:18432
    v_mul_f32 v61, v61, v81
    v_cvt_pk_bf16_f32 v33, v57, v61
    s_waitcnt lgkmcnt(10)
    v_mfma_f32_16x16x32_bf16 v[64:67], v[232:235], v[176:179], v[64:67]
    ds_read_b128 v[220:223], v91 offset:18432
    v_mul_f32 v58, v58, v82
    v_mul_f32 v62, v62, v82
    s_waitcnt lgkmcnt(10)
    v_mfma_f32_16x16x32_bf16 v[68:71], v[232:235], v[180:183], v[68:71]
    v_cvt_pk_bf16_f32 v37, v58, v62
    v_mul_f32 v59, v59, v83
    s_waitcnt lgkmcnt(9)
    v_mfma_f32_16x16x32_bf16 v[64:67], v[236:239], v[184:187], v[64:67]
    v_mul_f32 v63, v63, v83
    v_cvt_pk_bf16_f32 v41, v59, v63
    s_waitcnt lgkmcnt(8)
    v_mfma_f32_16x16x32_bf16 v[68:71], v[236:239], v[188:191], v[68:71]
    s_waitcnt lgkmcnt(7)
    v_mfma_f32_16x16x32_bf16 v[72:75], v[224:227], v[192:195], 0
    s_waitcnt lgkmcnt(6)
    v_mfma_f32_16x16x32_bf16 v[76:79], v[224:227], v[196:199], 0
    s_waitcnt lgkmcnt(5)
    v_mfma_f32_16x16x32_bf16 v[72:75], v[228:231], v[200:203], v[72:75]
    s_waitcnt lgkmcnt(4)
    v_mfma_f32_16x16x32_bf16 v[76:79], v[228:231], v[204:207], v[76:79]
    s_waitcnt lgkmcnt(3)
    v_mfma_f32_16x16x32_bf16 v[72:75], v[232:235], v[208:211], v[72:75]
    v_mul_f32 v64, v64, v80
    v_mul_f32 v68, v68, v80
    s_waitcnt lgkmcnt(2)
    v_mfma_f32_16x16x32_bf16 v[76:79], v[232:235], v[212:215], v[76:79]
    v_cvt_pk_bf16_f32 v30, v64, v68
    v_mul_f32 v65, v65, v81
    s_waitcnt lgkmcnt(1)
    v_mfma_f32_16x16x32_bf16 v[72:75], v[236:239], v[216:219], v[72:75]
    v_mul_f32 v69, v69, v81
    v_cvt_pk_bf16_f32 v34, v65, v69
    s_waitcnt lgkmcnt(0)
    v_mfma_f32_16x16x32_bf16 v[76:79], v[236:239], v[220:223], v[76:79]
    v_mul_f32 v66, v66, v82
    v_mul_f32 v70, v70, v82
    v_cvt_pk_bf16_f32 v38, v66, v70
    v_mul_f32 v67, v67, v83
    v_mul_f32 v71, v71, v83
    v_cvt_pk_bf16_f32 v42, v67, v71
    s_nop 1
    v_mul_f32 v72, v72, v80
    v_mul_f32 v76, v76, v80
    v_cvt_pk_bf16_f32 v31, v72, v76
    buffer_store_dwordx4 v[28:31], v14, s[20:23], s3 offen offset:0 nt
    v_mul_f32 v73, v73, v81
    v_mul_f32 v77, v77, v81
    v_cvt_pk_bf16_f32 v35, v73, v77
    buffer_store_dwordx4 v[32:35], v14, s[20:23], s3 offen offset:256 nt
    v_mul_f32 v74, v74, v82
    v_mul_f32 v78, v78, v82
    v_cvt_pk_bf16_f32 v39, v74, v78
    buffer_store_dwordx4 v[36:39], v14, s[20:23], s3 offen offset:512 nt
    v_mul_f32 v75, v75, v83
    v_mul_f32 v79, v79, v83
    v_cvt_pk_bf16_f32 v43, v75, v79
    buffer_store_dwordx4 v[40:43], v14, s[20:23], s3 offen offset:768 nt
    s_nop 1
    s_add_u32 s3, s3, 4096
    v_mfma_f32_16x16x32_bf16 v[80:83], v[240:243], v[16:19], 0
    v_mfma_f32_16x16x32_bf16 v[80:83], v[244:247], v[20:23], v[80:83]
    v_mfma_f32_16x16x32_bf16 v[80:83], v[248:251], v[24:27], v[80:83]
    v_mfma_f32_16x16x32_bf16 v[80:83], v[252:255], v[44:47], v[80:83]
    v_mfma_f32_16x16x32_bf16 v[48:51], v[240:243], v[96:99], 0
    v_mfma_f32_16x16x32_bf16 v[52:55], v[240:243], v[100:103], 0
    v_mfma_f32_16x16x32_bf16 v[48:51], v[244:247], v[104:107], v[48:51]
    v_mfma_f32_16x16x32_bf16 v[52:55], v[244:247], v[108:111], v[52:55]
    v_mfma_f32_16x16x32_bf16 v[48:51], v[248:251], v[112:115], v[48:51]
    v_mfma_f32_16x16x32_bf16 v[52:55], v[248:251], v[116:119], v[52:55]
    v_mfma_f32_16x16x32_bf16 v[48:51], v[252:255], v[120:123], v[48:51]
    v_mfma_f32_16x16x32_bf16 v[52:55], v[252:255], v[124:127], v[52:55]
    v_mfma_f32_16x16x32_bf16 v[56:59], v[240:243], v[128:131], 0
    v_add_f32 v80, s31, v80
    v_add_f32 v81, s31, v81
    v_mfma_f32_16x16x32_bf16 v[60:63], v[240:243], v[132:135], 0
    v_add_f32 v82, s31, v82
    v_add_f32 v83, s31, v83
    v_mfma_f32_16x16x32_bf16 v[56:59], v[244:247], v[136:139], v[56:59]
    v_cvt_pk_bf16_f32 v80, v80, v81
    v_cvt_pk_bf16_f32 v82, v82, v83
    v_mfma_f32_16x16x32_bf16 v[60:63], v[244:247], v[140:143], v[60:63]
    v_and_b32 v81, s32, v80
    v_and_b32 v83, s32, v82
    v_mfma_f32_16x16x32_bf16 v[56:59], v[248:251], v[144:147], v[56:59]
    v_lshlrev_b32 v80, 16, v80
    v_lshlrev_b32 v82, 16, v82
    v_mfma_f32_16x16x32_bf16 v[60:63], v[248:251], v[148:151], v[60:63]
    v_rcp_f32 v80, v80
    v_mfma_f32_16x16x32_bf16 v[56:59], v[252:255], v[152:155], v[56:59]
    v_rcp_f32 v81, v81
    v_mfma_f32_16x16x32_bf16 v[60:63], v[252:255], v[156:159], v[60:63]
    v_rcp_f32 v82, v82
    v_mfma_f32_16x16x32_bf16 v[64:67], v[240:243], v[160:163], 0
    v_rcp_f32 v83, v83
    v_mfma_f32_16x16x32_bf16 v[68:71], v[240:243], v[164:167], 0
    v_mul_f32 v48, v48, v80
    v_mul_f32 v52, v52, v80
    v_mfma_f32_16x16x32_bf16 v[64:67], v[244:247], v[168:171], v[64:67]
    v_cvt_pk_bf16_f32 v28, v48, v52
    v_mul_f32 v49, v49, v81
    v_mfma_f32_16x16x32_bf16 v[68:71], v[244:247], v[172:175], v[68:71]
    v_mul_f32 v53, v53, v81
    v_cvt_pk_bf16_f32 v32, v49, v53
    v_mfma_f32_16x16x32_bf16 v[64:67], v[248:251], v[176:179], v[64:67]
    v_mul_f32 v50, v50, v82
    v_mul_f32 v54, v54, v82
    v_mfma_f32_16x16x32_bf16 v[68:71], v[248:251], v[180:183], v[68:71]
    v_cvt_pk_bf16_f32 v36, v50, v54
    v_mul_f32 v51, v51, v83
    v_mfma_f32_16x16x32_bf16 v[64:67], v[252:255], v[184:187], v[64:67]
    v_mul_f32 v55, v55, v83
    v_cvt_pk_bf16_f32 v40, v51, v55
    v_mfma_f32_16x16x32_bf16 v[68:71], v[252:255], v[188:191], v[68:71]
    v_mul_f32 v56, v56, v80
    v_mul_f32 v60, v60, v80
    v_mfma_f32_16x16x32_bf16 v[72:75], v[240:243], v[192:195], 0
    v_cvt_pk_bf16_f32 v29, v56, v60
    v_mul_f32 v57, v57, v81
    v_mfma_f32_16x16x32_bf16 v[76:79], v[240:243], v[196:199], 0
    v_mul_f32 v61, v61, v81
    v_cvt_pk_bf16_f32 v33, v57, v61
    v_mfma_f32_16x16x32_bf16 v[72:75], v[244:247], v[200:203], v[72:75]
    v_mul_f32 v58, v58, v82
    v_mul_f32 v62, v62, v82
    v_mfma_f32_16x16x32_bf16 v[76:79], v[244:247], v[204:207], v[76:79]
    v_cvt_pk_bf16_f32 v37, v58, v62
    v_mul_f32 v59, v59, v83
    v_mfma_f32_16x16x32_bf16 v[72:75], v[248:251], v[208:211], v[72:75]
    v_mul_f32 v63, v63, v83
    v_cvt_pk_bf16_f32 v41, v59, v63
    v_mfma_f32_16x16x32_bf16 v[76:79], v[248:251], v[212:215], v[76:79]
    v_mul_f32 v64, v64, v80
    v_mul_f32 v68, v68, v80
    v_mfma_f32_16x16x32_bf16 v[72:75], v[252:255], v[216:219], v[72:75]
    v_cvt_pk_bf16_f32 v30, v64, v68
    v_mul_f32 v65, v65, v81
    v_mfma_f32_16x16x32_bf16 v[76:79], v[252:255], v[220:223], v[76:79]
    v_mul_f32 v69, v69, v81
    v_cvt_pk_bf16_f32 v34, v65, v69
    v_mul_f32 v66, v66, v82
    v_mul_f32 v70, v70, v82
    v_cvt_pk_bf16_f32 v38, v66, v70
    v_mul_f32 v67, v67, v83
    v_mul_f32 v71, v71, v83
    v_cvt_pk_bf16_f32 v42, v67, v71
    v_mul_f32 v72, v72, v80
    v_mul_f32 v76, v76, v80
    v_cvt_pk_bf16_f32 v31, v72, v76
    buffer_store_dwordx4 v[28:31], v14, s[20:23], s3 offen offset:0 nt
    v_mul_f32 v73, v73, v81
    v_mul_f32 v77, v77, v81
    v_cvt_pk_bf16_f32 v35, v73, v77
    buffer_store_dwordx4 v[32:35], v14, s[20:23], s3 offen offset:256 nt
    v_mul_f32 v74, v74, v82
    v_mul_f32 v78, v78, v82
    v_cvt_pk_bf16_f32 v39, v74, v78
    buffer_store_dwordx4 v[36:39], v14, s[20:23], s3 offen offset:512 nt
    v_mul_f32 v75, v75, v83
    v_mul_f32 v79, v79, v83
    v_cvt_pk_bf16_f32 v43, v75, v79
    buffer_store_dwordx4 v[40:43], v14, s[20:23], s3 offen offset:768 nt
    s_nop 1
standalone__linear_attn_elu__prompt_kernel_end:
    s_endpgm
standalone__linear_attn_elu__prompt_kernel_fslow:
    v_cmp_eq_u32 vcc, v128, v130
    s_cbranch_vccnz standalone__linear_attn_elu__prompt_kernel_fs_x
    s_add_u32 s54, s54, 1
    s_and_b32 s5, s54, 63
    s_cbranch_scc1 standalone__linear_attn_elu__prompt_kernel_fs_i
    v_mov_b32 v126, s34
    v_mov_b32 v127, s33
    s_mov_b64 exec, 1
    global_store_byte v126, v127, s[28:29] sc1
    s_mov_b64 exec, -1
    s_cmp_ge_u32 s54, 16384
    s_cbranch_scc1 standalone__linear_attn_elu__prompt_kernel_fok
    s_lshl_b32 s5, s35, 3
    s_add_u32 s5, s5, s4
    v_mov_b32 v126, s5
    global_load_ubyte v126, v126, s[28:29] sc1
    s_waitcnt vmcnt(0)
    v_and_b32 v129, 15, v126
    v_cmp_ne_u32 vcc, 0, v126
    s_cbranch_vccnz standalone__linear_attn_elu__prompt_kernel_fs_x
standalone__linear_attn_elu__prompt_kernel_fs_i:
    buffer_load_dwordx2 v[128:129], v11, s[24:27], s51 offen sc1
    s_waitcnt vmcnt(0)
    s_branch standalone__linear_attn_elu__prompt_kernel_fslow
standalone__linear_attn_elu__prompt_kernel_fs_x:
    v_cmp_eq_u32 vcc, v129, v131
    s_cbranch_vccnz standalone__linear_attn_elu__prompt_kernel_fok
    v_mov_b32 v126, 1
    ds_write_b32 v132, v126
    s_branch standalone__linear_attn_elu__prompt_kernel_fok
standalone__linear_attn_elu__prompt_kernel_fb1:
    s_add_u32 s24, s46, 33554432
    s_addc_u32 s25, s47, 0
    s_mov_b32 s96, s24
    s_mov_b32 s97, s25
    s_mov_b32 s26, 234881024
    buffer_store_dwordx4 v[96:99], v136, s[96:99], s59 offen sc1
    s_cmp_eq_u32 s53, 0
    s_cbranch_scc1 standalone__linear_attn_elu__prompt_kernel_fbz
    v_lshlrev_b32 v14, 1, v1
    s_lshl_b32 s5, s57, 7
    s_add_u32 s5, s5, s52
    s_add_u32 s5, s5, 20971520
    v_min_u32 v112, -2, v112
    v_min_u32 v116, -2, v116
    s_mov_b32 exec_lo, 0x10001
    s_mov_b32 exec_hi, 0x10001
    buffer_store_dwordx4 v[112:115], v14, s[24:27], s5 offen sc1
    buffer_store_dwordx4 v[116:119], v14, s[24:27], s5 offen offset:16 sc1
    s_mov_b64 exec, -1
standalone__linear_attn_elu__prompt_kernel_fbz:
    v_cvt_pk_bf16_f32 v100, v104, v105
    v_cvt_pk_bf16_f32 v101, v106, v107
    v_cvt_pk_bf16_f32 v102, v108, v109
    v_cvt_pk_bf16_f32 v103, v110, v111
    v_min_u32 v100, -2, v100
    s_not_b64 exec, s[60:61]
    buffer_store_dwordx4 v[100:103], v138, s[24:27], s62 offen sc1
    s_mov_b64 exec, -1
    s_waitcnt vmcnt(0)
    s_barrier
    s_add_u32 s33, s33, 16
    v_mov_b32 v126, s34
    v_mov_b32 v127, s33
    s_cmp_lg_u32 s4, 0
    s_cbranch_scc1 standalone__linear_attn_elu__prompt_kernel_gb1_l
    s_mov_b64 exec, 1
    global_store_byte v126, v127, s[28:29] sc1
    s_mov_b64 exec, -1
standalone__linear_attn_elu__prompt_kernel_gb1_l:
    v_and_b32 v126, 7, v1
    v_lshl_add_u32 v126, s35, 3, v126
    global_load_ubyte v126, v126, s[28:29] sc1
    s_add_u32 s54, s54, 1
    s_waitcnt vmcnt(0)
    v_cmp_gt_u32 vcc, 144, v126
    s_cbranch_vccz standalone__linear_attn_elu__prompt_kernel_gb1_d
    s_cmp_lt_u32 s54, 16384
    s_cbranch_scc1 standalone__linear_attn_elu__prompt_kernel_gb1_l
standalone__linear_attn_elu__prompt_kernel_gb1_d:
    s_branch standalone__linear_attn_elu__prompt_kernel_snd2
standalone__linear_attn_elu__prompt_kernel_fsc:
    buffer_store_dwordx4 v[76:79], v10, s[24:27], s63 offen sc1
    s_branch standalone__linear_attn_elu__prompt_kernel_fsc_x
standalone__linear_attn_elu__prompt_kernel_gb2o:
    s_waitcnt vmcnt(0)
    s_barrier
    s_add_u32 s33, s33, 16
    v_mov_b32 v126, s34
    v_mov_b32 v127, s33
    s_cmp_lg_u32 s4, 0
    s_cbranch_scc1 standalone__linear_attn_elu__prompt_kernel_gb2oi_l
    s_mov_b64 exec, 1
    global_store_byte v126, v127, s[28:29] sc1
    s_mov_b64 exec, -1
standalone__linear_attn_elu__prompt_kernel_gb2oi_l:
    v_and_b32 v126, 7, v1
    v_lshl_add_u32 v126, s35, 3, v126
    global_load_ubyte v126, v126, s[28:29] sc1
    s_add_u32 s54, s54, 1
    s_waitcnt vmcnt(0)
    v_cmp_gt_u32 vcc, 160, v126
    s_cbranch_vccz standalone__linear_attn_elu__prompt_kernel_gb2oi_d
    s_cmp_lt_u32 s54, 16384
    s_cbranch_scc1 standalone__linear_attn_elu__prompt_kernel_gb2oi_l
standalone__linear_attn_elu__prompt_kernel_gb2oi_d:
    s_branch standalone__linear_attn_elu__prompt_kernel_gb2o_x
standalone__linear_attn_elu__prompt_kernel_ce_r:
    s_add_u32 s54, s54, 1
    s_and_b32 s5, s54, 63
    s_cbranch_scc1 standalone__linear_attn_elu__prompt_kernel_ce_i
    v_mov_b32 v126, s34
    v_mov_b32 v127, s33
    s_mov_b64 exec, 1
    global_store_byte v126, v127, s[28:29] sc1
    s_mov_b64 exec, -1
    s_cmp_ge_u32 s54, 16384
    s_cbranch_scc1 standalone__linear_attn_elu__prompt_kernel_ce_ok
standalone__linear_attn_elu__prompt_kernel_ce_i:
    s_and_b32 s5, s100, 1
    s_cbranch_scc1 standalone__linear_attn_elu__prompt_kernel_er1
    s_or_b32 s100, s100, 1
    s_add_u32 m0, s92, 32768
    s_add_u32 s5, s3, 4096
    buffer_load_dwordx4 v220, s[16:19], s5 offen nt lds
    s_add_u32 m0, s92, 40960
    s_add_u32 s5, s3, 4096
    buffer_load_dwordx4 v221, s[16:19], s5 offen nt lds
    buffer_load_dword v135, v134, s[24:27], s93 offen sc1 nt
    s_waitcnt lgkmcnt(0)
    s_waitcnt vmcnt(3)
    ds_read_b128 v[232:235], v11 offset:16384
    ds_read_b128 v[236:239], v12 offset:16384
    s_waitcnt lgkmcnt(0)
    v_lshlrev_b32 v28, 16, v232
    v_and_b32 v29, s32, v232
    v_lshlrev_b32 v30, 16, v233
    v_and_b32 v31, s32, v233
    v_lshlrev_b32 v32, 16, v234
    v_and_b32 v33, s32, v234
    v_lshlrev_b32 v34, 16, v235
    v_and_b32 v35, s32, v235
    v_pk_mul_f32 v[36:37], v[28:29], s[30:31] op_sel_hi:[1,0]
    v_pk_mul_f32 v[38:39], v[30:31], s[30:31] op_sel_hi:[1,0]
    v_pk_mul_f32 v[40:41], v[32:33], s[30:31] op_sel_hi:[1,0]
    v_pk_mul_f32 v[42:43], v[34:35], s[30:31] op_sel_hi:[1,0]
    v_exp_f32_e64 v36, v36 clamp
    v_max_f32 v28, s31, v28
    v_exp_f32_e64 v37, v37 clamp
    v_max_f32 v29, s31, v29
    v_exp_f32_e64 v38, v38 clamp
    v_max_f32 v30, s31, v30
    v_exp_f32_e64 v39, v39 clamp
    v_max_f32 v31, s31, v31
    v_exp_f32_e64 v40, v40 clamp
    v_max_f32 v32, s31, v32
    v_exp_f32_e64 v41, v41 clamp
    v_max_f32 v33, s31, v33
    v_exp_f32_e64 v42, v42 clamp
    v_max_f32 v34, s31, v34
    v_exp_f32_e64 v43, v43 clamp
    v_max_f32 v35, s31, v35
    v_pk_add_f32 v[28:29], v[36:37], v[28:29]
    v_pk_add_f32 v[30:31], v[38:39], v[30:31]
    v_pk_add_f32 v[32:33], v[40:41], v[32:33]
    v_pk_add_f32 v[34:35], v[42:43], v[34:35]
    v_cvt_pk_bf16_f32 v232, v28, v29
    v_cvt_pk_bf16_f32 v233, v30, v31
    v_cvt_pk_bf16_f32 v234, v32, v33
    v_cvt_pk_bf16_f32 v235, v34, v35
    v_lshlrev_b32 v28, 16, v236
    v_and_b32 v29, s32, v236
    v_lshlrev_b32 v30, 16, v237
    v_and_b32 v31, s32, v237
    v_lshlrev_b32 v32, 16, v238
    v_and_b32 v33, s32, v238
    v_lshlrev_b32 v34, 16, v239
    v_and_b32 v35, s32, v239
    v_pk_mul_f32 v[36:37], v[28:29], s[30:31] op_sel_hi:[1,0]
    v_pk_mul_f32 v[38:39], v[30:31], s[30:31] op_sel_hi:[1,0]
    v_pk_mul_f32 v[40:41], v[32:33], s[30:31] op_sel_hi:[1,0]
    v_pk_mul_f32 v[42:43], v[34:35], s[30:31] op_sel_hi:[1,0]
    v_exp_f32_e64 v36, v36 clamp
    v_max_f32 v28, s31, v28
    v_exp_f32_e64 v37, v37 clamp
    v_max_f32 v29, s31, v29
    v_exp_f32_e64 v38, v38 clamp
    v_max_f32 v30, s31, v30
    v_exp_f32_e64 v39, v39 clamp
    v_max_f32 v31, s31, v31
    v_exp_f32_e64 v40, v40 clamp
    v_max_f32 v32, s31, v32
    v_exp_f32_e64 v41, v41 clamp
    v_max_f32 v33, s31, v33
    v_exp_f32_e64 v42, v42 clamp
    v_max_f32 v34, s31, v34
    v_exp_f32_e64 v43, v43 clamp
    v_max_f32 v35, s31, v35
    v_pk_add_f32 v[28:29], v[36:37], v[28:29]
    v_pk_add_f32 v[30:31], v[38:39], v[30:31]
    v_pk_add_f32 v[32:33], v[40:41], v[32:33]
    v_pk_add_f32 v[34:35], v[42:43], v[34:35]
    v_cvt_pk_bf16_f32 v236, v28, v29
    v_cvt_pk_bf16_f32 v237, v30, v31
    v_cvt_pk_bf16_f32 v238, v32, v33
    v_cvt_pk_bf16_f32 v239, v34, v35
    s_branch standalone__linear_attn_elu__prompt_kernel_er1x
standalone__linear_attn_elu__prompt_kernel_er1:
    buffer_load_dword v135, v134, s[24:27], s93 offen sc1 nt
standalone__linear_attn_elu__prompt_kernel_er1x:
    s_waitcnt vmcnt(0)
    s_branch standalone__linear_attn_elu__prompt_kernel_ce_c
standalone__linear_attn_elu__prompt_kernel_fin_r:
    s_add_u32 s54, s54, 1
    s_and_b32 s5, s54, 63
    s_cbranch_scc1 standalone__linear_attn_elu__prompt_kernel_fin_i
    v_mov_b32 v126, s34
    v_mov_b32 v127, s33
    s_mov_b64 exec, 1
    global_store_byte v126, v127, s[28:29] sc1
    s_mov_b64 exec, -1
    s_cmp_ge_u32 s54, 16384
    s_cbranch_scc1 standalone__linear_attn_elu__prompt_kernel_fin_ok
standalone__linear_attn_elu__prompt_kernel_fin_i:
    s_and_b32 s5, s100, 2
    s_cbranch_scc1 standalone__linear_attn_elu__prompt_kernel_er2
    s_or_b32 s100, s100, 2
    buffer_load_dwordx4 v[156:159], v138, s[24:27], s95 offen sc1 nt
    s_waitcnt lgkmcnt(0)
    s_waitcnt vmcnt(1)
    ds_read_b128 v[240:243], v11 offset:32768
    ds_read_b128 v[244:247], v12 offset:32768
    s_waitcnt lgkmcnt(0)
    v_lshlrev_b32 v28, 16, v240
    v_and_b32 v29, s32, v240
    v_lshlrev_b32 v30, 16, v241
    v_and_b32 v31, s32, v241
    v_lshlrev_b32 v32, 16, v242
    v_and_b32 v33, s32, v242
    v_lshlrev_b32 v34, 16, v243
    v_and_b32 v35, s32, v243
    v_pk_mul_f32 v[36:37], v[28:29], s[30:31] op_sel_hi:[1,0]
    v_pk_mul_f32 v[38:39], v[30:31], s[30:31] op_sel_hi:[1,0]
    v_pk_mul_f32 v[40:41], v[32:33], s[30:31] op_sel_hi:[1,0]
    v_pk_mul_f32 v[42:43], v[34:35], s[30:31] op_sel_hi:[1,0]
    v_exp_f32_e64 v36, v36 clamp
    v_max_f32 v28, s31, v28
    v_exp_f32_e64 v37, v37 clamp
    v_max_f32 v29, s31, v29
    v_exp_f32_e64 v38, v38 clamp
    v_max_f32 v30, s31, v30
    v_exp_f32_e64 v39, v39 clamp
    v_max_f32 v31, s31, v31
    v_exp_f32_e64 v40, v40 clamp
    v_max_f32 v32, s31, v32
    v_exp_f32_e64 v41, v41 clamp
    v_max_f32 v33, s31, v33
    v_exp_f32_e64 v42, v42 clamp
    v_max_f32 v34, s31, v34
    v_exp_f32_e64 v43, v43 clamp
    v_max_f32 v35, s31, v35
    v_pk_add_f32 v[28:29], v[36:37], v[28:29]
    v_pk_add_f32 v[30:31], v[38:39], v[30:31]
    v_pk_add_f32 v[32:33], v[40:41], v[32:33]
    v_pk_add_f32 v[34:35], v[42:43], v[34:35]
    v_cvt_pk_bf16_f32 v240, v28, v29
    v_cvt_pk_bf16_f32 v241, v30, v31
    v_cvt_pk_bf16_f32 v242, v32, v33
    v_cvt_pk_bf16_f32 v243, v34, v35
    v_lshlrev_b32 v28, 16, v244
    v_and_b32 v29, s32, v244
    v_lshlrev_b32 v30, 16, v245
    v_and_b32 v31, s32, v245
    v_lshlrev_b32 v32, 16, v246
    v_and_b32 v33, s32, v246
    v_lshlrev_b32 v34, 16, v247
    v_and_b32 v35, s32, v247
    v_pk_mul_f32 v[36:37], v[28:29], s[30:31] op_sel_hi:[1,0]
    v_pk_mul_f32 v[38:39], v[30:31], s[30:31] op_sel_hi:[1,0]
    v_pk_mul_f32 v[40:41], v[32:33], s[30:31] op_sel_hi:[1,0]
    v_pk_mul_f32 v[42:43], v[34:35], s[30:31] op_sel_hi:[1,0]
    v_exp_f32_e64 v36, v36 clamp
    v_max_f32 v28, s31, v28
    v_exp_f32_e64 v37, v37 clamp
    v_max_f32 v29, s31, v29
    v_exp_f32_e64 v38, v38 clamp
    v_max_f32 v30, s31, v30
    v_exp_f32_e64 v39, v39 clamp
    v_max_f32 v31, s31, v31
    v_exp_f32_e64 v40, v40 clamp
    v_max_f32 v32, s31, v32
    v_exp_f32_e64 v41, v41 clamp
    v_max_f32 v33, s31, v33
    v_exp_f32_e64 v42, v42 clamp
    v_max_f32 v34, s31, v34
    v_exp_f32_e64 v43, v43 clamp
    v_max_f32 v35, s31, v35
    v_pk_add_f32 v[28:29], v[36:37], v[28:29]
    v_pk_add_f32 v[30:31], v[38:39], v[30:31]
    v_pk_add_f32 v[32:33], v[40:41], v[32:33]
    v_pk_add_f32 v[34:35], v[42:43], v[34:35]
    v_cvt_pk_bf16_f32 v244, v28, v29
    v_cvt_pk_bf16_f32 v245, v30, v31
    v_cvt_pk_bf16_f32 v246, v32, v33
    v_cvt_pk_bf16_f32 v247, v34, v35
    s_branch standalone__linear_attn_elu__prompt_kernel_er2x
standalone__linear_attn_elu__prompt_kernel_er2:
    buffer_load_dwordx4 v[156:159], v138, s[24:27], s95 offen sc1 nt
standalone__linear_attn_elu__prompt_kernel_er2x:
    s_waitcnt vmcnt(0)
    s_branch standalone__linear_attn_elu__prompt_kernel_fin_c
standalone__linear_attn_elu__prompt_kernel_zz_r:
    s_add_u32 s54, s54, 1
    s_and_b32 s5, s54, 63
    s_cbranch_scc1 standalone__linear_attn_elu__prompt_kernel_zz_i
    v_mov_b32 v126, s34
    v_mov_b32 v127, s33
    s_mov_b64 exec, 1
    global_store_byte v126, v127, s[28:29] sc1
    s_mov_b64 exec, -1
    s_cmp_ge_u32 s54, 16384
    s_cbranch_scc1 standalone__linear_attn_elu__prompt_kernel_zz_ok
standalone__linear_attn_elu__prompt_kernel_zz_i:
    s_add_u32 s6, s56, 20971520
    buffer_load_dwordx4 v[48:51], v64, s[24:27], s6 offen offset:0 sc1 nt
    buffer_load_dwordx4 v[52:55], v64, s[24:27], s6 offen offset:256 sc1 nt
    buffer_load_dwordx4 v[56:59], v64, s[24:27], s6 offen offset:512 sc1 nt
    buffer_load_dwordx4 v[60:63], v64, s[24:27], s6 offen offset:768 sc1 nt
    s_waitcnt vmcnt(0)
    s_branch standalone__linear_attn_elu__prompt_kernel_zz_c
standalone__linear_attn_elu__prompt_kernel_go_r:
    s_add_u32 s54, s54, 1
    s_and_b32 s5, s54, 63
    s_cbranch_scc1 standalone__linear_attn_elu__prompt_kernel_go_i
    v_mov_b32 v126, s34
    v_mov_b32 v127, s33
    s_mov_b64 exec, 1
    global_store_byte v126, v127, s[28:29] sc1
    s_mov_b64 exec, -1
    s_cmp_ge_u32 s54, 16384
    s_cbranch_scc1 standalone__linear_attn_elu__prompt_kernel_go_ok
standalone__linear_attn_elu__prompt_kernel_go_i:
    s_mov_b32 m0, s55
    s_nop 0
    buffer_load_dwordx4 v9, s[24:27], s51 offen offset:0 sc1 nt lds
    buffer_load_dwordx4 v9, s[24:27], s51 offen offset:1024 sc1 nt lds
    buffer_load_dwordx4 v9, s[24:27], s51 offen offset:2048 sc1 nt lds
    buffer_load_dwordx4 v9, s[24:27], s51 offen offset:3072 sc1 nt lds
    s_waitcnt vmcnt(0)
    s_branch standalone__linear_attn_elu__prompt_kernel_go_c
.section .rodata,"a"
.p2align 6
.amdhsa_kernel standalone__linear_attn_elu__prompt_kernel
  .amdhsa_next_free_vgpr 256
  .amdhsa_next_free_sgpr 102
  .amdhsa_accum_offset 256
  .amdhsa_group_segment_fixed_size 0
  .amdhsa_kernarg_size 48
  .amdhsa_user_sgpr_count 2
  .amdhsa_user_sgpr_kernarg_segment_ptr 1
  .amdhsa_system_sgpr_workgroup_id_x 1
  .amdhsa_float_denorm_mode_32 3
.end_amdhsa_kernel
```
